```python
import torch

def _softmax(x, axis=-1):
    return torch.softmax(x, dim=axis)

def _gelu(x):
    return torch.nn.functional.gelu(x, approximate='tanh')

def _silu(x):
    return torch.nn.functional.silu(x)

def _sigmoid(x):
    return torch.sigmoid(x)

def _layernorm(x, axis=-1, eps=1e-05):
    m = x.mean(dim=axis, keepdim=True)
    v = x.var(dim=axis, keepdim=True, unbiased=False)
    return (x - m) / torch.sqrt(v + eps)

def _scatter_add(tgt, idx, src, axis=0):
    return tgt.clone().index_add_(axis, idx, src)

def _segment_sum(src, seg, n):
    out = torch.zeros((n,) + src.shape[1:], dtype=src.dtype)
    return out.index_add_(0, seg, src)

def _pad(x, pw):
    flat = tuple((v for pair in reversed(pw) for v in pair))
    return torch.nn.functional.pad(x, flat)
kernel_name = 'gated_mix__ssm_conv_s5__mixer_gmlp__prompt'

def setup_inputs():

    _w = lambda a: (lambda t: t.to(torch.bfloat16) if t.is_floating_point() else t)(torch.as_tensor(a))

    def _A_setup():
        B, S, D = (1, 2048, 512)
        P = D
        Lambda_re = -0.5 * (lambda _x: torch.exp(torch.as_tensor(_x)))((lambda *s: torch.randn(*s, dtype=torch.bfloat16) * 0.8)(P))
        Lambda_im = (lambda *s: torch.randn(*s, dtype=torch.bfloat16) * 0.8)(P) * 1.0
        B_re = (lambda *s: torch.randn(*s, dtype=torch.bfloat16) * 0.8)(P, D) * D ** (-0.5)
        B_im = (lambda *s: torch.randn(*s, dtype=torch.bfloat16) * 0.8)(P, D) * D ** (-0.5)
        C_re = (lambda *s: torch.randn(*s, dtype=torch.bfloat16) * 0.8)(D, P) * P ** (-0.5)
        C_im = (lambda *s: torch.randn(*s, dtype=torch.bfloat16) * 0.8)(D, P) * P ** (-0.5)
        log_dt = (lambda *s: torch.randn(*s, dtype=torch.bfloat16) * 0.8)(P) * 0.3 - 2.0
        Dskip = (lambda *s: torch.randn(*s, dtype=torch.bfloat16) * 0.8)(D)
        return {'x': _w((lambda *s: torch.randn(*s, dtype=torch.bfloat16) * 0.05)(B, S, D)), 'Lambda_re': _w(Lambda_re), 'Lambda_im': _w(Lambda_im), 'B_re': _w(B_re), 'B_im': _w(B_im), 'C_re': _w(C_re), 'C_im': _w(C_im), 'log_dt': _w(log_dt), 'Dskip': _w(Dskip)}
    _A_in = _A_setup()

    def _B_setup():
        B, S, D, F = (1, 2048, 512, 1376)
        Fh = F // 2
        return {'x': _w((lambda *s: torch.randn(*s, dtype=torch.bfloat16) * 0.05)(B, S, D)), 'w_in': _w((lambda *s: torch.randn(*s, dtype=torch.bfloat16) * 0.2)(D, 2 * Fh)), 'w_sp': _w(0.01 * (lambda *s: torch.randn(*s, dtype=torch.bfloat16) * 0.2)(S, S)), 'b_sp': _w(1.0 + 0.01 * (lambda *s: torch.randn(*s, dtype=torch.bfloat16) * 0.05)(S)), 'w_out': _w((lambda *s: torch.randn(*s, dtype=torch.bfloat16) * 0.05)(Fh, D))}
    _B_in = _B_setup()
    return {'A_x': _A_in['x'], 'A_Lambda_re': _A_in['Lambda_re'], 'A_Lambda_im': _A_in['Lambda_im'], 'A_B_re': _A_in['B_re'], 'A_B_im': _A_in['B_im'], 'A_C_re': _A_in['C_re'], 'A_C_im': _A_in['C_im'], 'A_log_dt': _A_in['log_dt'], 'A_Dskip': _A_in['Dskip'], 'B_x': _B_in['x'], 'B_w_in': _B_in['w_in'], 'B_w_sp': _B_in['w_sp'], 'B_b_sp': _B_in['b_sp'], 'B_w_out': _B_in['w_out'], 'gate_w': _w((lambda *s: torch.randn(*s, dtype=torch.bfloat16) * 0.05)(512) * 16.0)}

def reference(A_x, A_Lambda_re, A_Lambda_im, A_B_re, A_B_im, A_C_re, A_C_im, A_log_dt, A_Dskip, B_x, B_w_in, B_w_sp, B_b_sp, B_w_out, gate_w):

    def _A_ref(x, Lambda_re, Lambda_im, B_re, B_im, C_re, C_im, log_dt, Dskip):
        Bsz, L, H = x.shape
        Lam = Lambda_re + 1j * Lambda_im
        Bmat = B_re + 1j * B_im
        Cmat = C_re + 1j * C_im
        dt = torch.exp(log_dt)
        Lam_bar = torch.exp(dt * Lam)
        B_bar = ((Lam_bar - 1.0) / Lam)[:, None] * Bmat
        Bu = torch.einsum('bld,pd->blp', x + 0j, B_bar)
        h = torch.zeros_like(Bu[:, 0, :])
        hs = []
        for t in range(L):
            h = Lam_bar[None, :] * h + Bu[:, t, :]
            hs.append(h)
        hseq = torch.stack(hs, 1)
        y = 2.0 * torch.einsum('blp,dp->bld', hseq, Cmat).real + x * Dskip[None, None, :]
        return y

    def _B_ref(x, w_in, w_sp, b_sp, w_out):
        B, S, D = x.shape
        F = w_in.shape[-1]
        Fh = F // 2
        z = _gelu(torch.einsum('bsd,df->bsf', x, w_in))
        z1 = z[..., :Fh].clone()
        z2 = _layernorm(z[..., Fh:], axis=-1)
        g = torch.einsum('ts,bsf->btf', w_sp, z2) + b_sp[None, :, None]
        return torch.einsum('bsf,fd->bsd', z1 * g, w_out)
    x = A_x
    g = _sigmoid((x * gate_w).sum(-1, keepdims=True))
    a = _A_ref(x, A_Lambda_re, A_Lambda_im, A_B_re, A_B_im, A_C_re, A_C_im, A_log_dt, A_Dskip)
    b = _B_ref(x, B_w_in, B_w_sp, B_b_sp, B_w_out)
    return g * a + (1 - g) * b
```

```asm
; @launch grid=(256,1,1) block=(256,1,1) lds=163840
.amdgcn_target "amdgcn-amd-amdhsa--gfx950"
.text
.globl gated_mix__ssm_conv_s5__mixer_gmlp__prompt_kernel
.p2align 8
.type gated_mix__ssm_conv_s5__mixer_gmlp__prompt_kernel,@function
gated_mix__ssm_conv_s5__mixer_gmlp__prompt_kernel:
    s_cmp_ge_u32 s2, 256
    s_cbranch_scc1 .Lend_1
    s_getpc_b64 s[64:65]
    v_lshlrev_b32 v4, 7, v0
    global_load_dword v5, v4, s[64:65]
    s_load_dwordx2 s[4:5], s[0:1], 0
    s_load_dwordx2 s[52:53], s[0:1], 80
    s_load_dwordx4 s[48:51], s[0:1], 24
    v_lshrrev_b32 v2, 6, v0
    v_and_b32 v1, 63, v0
    v_readfirstlane_b32 s56, v2
    s_and_b32 s60, s2, 6
    s_lshl_b32 s60, s60, 1
    s_bfe_u32 s57, s2, 0x20005
    s_add_u32 s57, s57, s60
    s_and_b32 s79, s2, 7
    s_mov_b32 s6, 2097152
    s_mov_b32 s7, 0x20000
    s_lshl_b32 s73, s57, 17
    s_cmp_ge_u32 s2, 128
    s_cbranch_scc1 .LU_2
    v_lshrrev_b32 v112, 3, v1
    v_mul_u32_u24 v112, 1024, v112
    v_and_b32 v113, 7, v1
    v_lshrrev_b32 v104, 4, v1
    v_xor_b32 v113, v113, v104
    v_lshlrev_b32 v113, 4, v113
    v_add_u32 v104, v113, v112
    v_xor_b32 v113, 64, v113
    v_add_u32 v105, v113, v112
    v_add_u32 v106, 14336, v104
    v_add_u32 v107, 21504, v105
    v_add_u32 v105, 7168, v105
    s_lshl_b32 s60, s56, 15
    s_add_u32 s73, s73, s60
    s_mul_i32 s96, s56, 40960
    s_mov_b32 m0, s96
    s_waitcnt lgkmcnt(0)
    s_mul_i32 s68, s79, 128
    s_add_u32 s68, s68, s73
    buffer_load_dwordx4 v104, s[4:7], s68 offen offset:0 lds
    buffer_load_dwordx4 v105, s[4:7], s68 offen offset:1024 lds
    buffer_load_dwordx4 v106, s[4:7], s68 offen offset:2048 lds
    buffer_load_dwordx4 v107, s[4:7], s68 offen offset:3072 lds
    s_branch .LZ_4
.LU_2:
    v_lshrrev_b32 v60, 5, v1
    v_lshlrev_b32 v60, 15, v60
    v_bfe_u32 v61, v1, 3, 1
    v_lshl_add_u32 v60, v61, 14, v60
    v_bfe_u32 v61, v1, 4, 1
    v_lshl_add_u32 v60, v61, 10, v60
    v_and_b32 v61, 7, v1
    v_lshrrev_b32 v206, 4, v1
    v_xor_b32 v61, v61, v206
    v_lshlrev_b32 v61, 4, v61
    v_add_u32 v206, v61, v60
    v_xor_b32 v61, 64, v61
    v_add_u32 v207, v61, v60
    v_add_u32 v208, 2048, v206
    v_add_u32 v209, 3072, v207
    v_add_u32 v207, 1024, v207
    s_lshr_b32 s89, s56, 1
    s_and_b32 s88, s56, 1
    s_lshl_b32 s60, s88, 5
    v_xor_b32 v206, s60, v206
    v_xor_b32 v207, s60, v207
    v_xor_b32 v208, s60, v208
    v_xor_b32 v209, s60, v209
    s_lshl_b32 s63, s89, 16
    s_add_u32 s73, s73, s63
    s_lshl_b32 s63, s88, 13
    s_add_u32 s73, s73, s63
    s_lshl_b32 s75, s56, 12
    s_mov_b32 m0, s75
    s_waitcnt lgkmcnt(0)
    s_mul_i32 s68, s79, 128
    s_add_u32 s68, s68, s73
    buffer_load_dwordx4 v206, s[4:7], s68 offen offset:0 lds
    buffer_load_dwordx4 v207, s[4:7], s68 offen offset:1024 lds
    buffer_load_dwordx4 v208, s[4:7], s68 offen offset:2048 lds
    buffer_load_dwordx4 v209, s[4:7], s68 offen offset:3072 lds
    v_lshlrev_b32 v2, 4, v1
    v_mov_b32 v3, 2147483648
    s_and_b32 s81, s2, 1
    s_lshl_b32 s62, s81, 2
    s_bfe_u32 s63, s2, 0x20003
    s_add_u32 s58, s62, s63
    s_mov_b32 s11, 0x20000
    v_lshrrev_b32 v60, 3, v1
    v_mul_u32_u24 v60, 1024, v60
    v_and_b32 v61, 7, v1
    v_lshrrev_b32 v210, 4, v1
    v_xor_b32 v61, v61, v210
    v_lshlrev_b32 v61, 4, v61
    v_add_u32 v210, v61, v60
    v_xor_b32 v61, 64, v61
    v_add_u32 v211, v61, v60
    v_add_u32 v212, 14336, v210
    v_add_u32 v213, 21504, v211
    v_add_u32 v211, 7168, v211
    s_lshl_b32 s74, s58, 16
    s_lshl_b32 s63, s88, 15
    s_add_u32 s74, s74, s63
    s_mov_b32 s10, 524288
    s_add_u32 m0, s75, 49152
    s_cmp_eq_u32 s89, 0
    s_cselect_b64 s[8:9], s[48:49], s[50:51]
    s_mul_i32 s68, s79, 128
    s_add_u32 s68, s68, s74
    buffer_load_dwordx4 v210, s[8:11], s68 offen offset:0 lds
    buffer_load_dwordx4 v211, s[8:11], s68 offen offset:1024 lds
    buffer_load_dwordx4 v212, s[8:11], s68 offen offset:2048 lds
    buffer_load_dwordx4 v213, s[8:11], s68 offen offset:3072 lds
    s_cmp_eq_u32 s58, 7
    s_cselect_b32 s83, 2, 12
    v_add_u32 v60, 0, v1
    v_mul_u32_u24 v61, 171, v60
    v_lshrrev_b32 v61, 11, v61
    v_mul_u32_u24 v62, 12, v61
    v_sub_u32 v60, v60, v62
    v_cmp_le_u32 vcc, s83, v60
    v_mul_u32_u24 v61, 2752, v61
    v_lshl_add_u32 v60, v60, 4, v61
    v_cndmask_b32 v214, v60, v3, vcc
    v_add_u32 v60, 64, v1
    v_mul_u32_u24 v61, 171, v60
    v_lshrrev_b32 v61, 11, v61
    v_mul_u32_u24 v62, 12, v61
    v_sub_u32 v60, v60, v62
    v_cmp_le_u32 vcc, s83, v60
    v_mul_u32_u24 v61, 2752, v61
    v_lshl_add_u32 v60, v60, 4, v61
    v_add_u32 v60, -1024, v60
    v_cndmask_b32 v215, v60, v3, vcc
    v_add_u32 v60, 128, v1
    v_mul_u32_u24 v61, 171, v60
    v_lshrrev_b32 v61, 11, v61
    v_mul_u32_u24 v62, 12, v61
    v_sub_u32 v60, v60, v62
    v_cmp_le_u32 vcc, s83, v60
    v_mul_u32_u24 v61, 2752, v61
    v_lshl_add_u32 v60, v60, 4, v61
    v_add_u32 v60, -2048, v60
    v_cndmask_b32 v216, v60, v3, vcc
    s_mul_i32 s78, s56, 44032
    s_mul_i32 s60, s58, 192
    s_add_u32 s78, s78, s60
    s_mul_i32 s76, s56, 3072
    s_add_u32 s76, s76, 98304
    s_mov_b32 m0, s76
    s_mov_b32 s54, 1409024
    s_mov_b32 s55, 0x20000
    s_mul_i32 s68, s79, 176128
    s_add_u32 s68, s68, s78
    buffer_load_dwordx4 v214, s[52:55], s68 offen offset:0 lds
    buffer_load_dwordx4 v215, s[52:55], s68 offen offset:1024 lds
    buffer_load_dwordx4 v216, s[52:55], s68 offen offset:2048 lds
    s_load_dwordx2 s[16:17], s[0:1], 136
    s_load_dwordx2 s[46:47], s[0:1], 112
    s_load_dwordx4 s[36:39], s[0:1], 8
    s_load_dwordx2 s[40:41], s[0:1], 56
    s_load_dwordx2 s[12:13], s[0:1], 88
    s_load_dwordx2 s[20:21], s[0:1], 40
    s_load_dwordx2 s[24:25], s[0:1], 48
    s_load_dwordx2 s[28:29], s[0:1], 104
    s_load_dwordx2 s[32:33], s[0:1], 120
    s_load_dwordx2 s[42:43], s[0:1], 64
    s_load_dwordx2 s[44:45], s[0:1], 96
    s_mov_b32 s14, 8388608
    s_mov_b32 s15, 0x20000
    s_add_u32 m0, s76, 12288
    s_add_u32 s68, s79, 1
    s_and_b32 s68, s68, 7
    s_mul_i32 s68, s68, 176128
    s_add_u32 s68, s68, s78
    s_mov_b32 s18, 20971520
    s_mov_b32 s19, 0x20000
    s_mov_b32 s22, 524288
    s_mov_b32 s23, 0x20000
    s_mov_b32 s26, 524288
    s_mov_b32 s27, 0x20000
    s_mov_b32 s30, 704512
    s_mov_b32 s31, 0x20000
    s_mov_b32 s34, 4194304
    s_mov_b32 s35, 0x20000
    s_and_b32 s62, s2, 6
    s_lshl_b32 s62, s62, 1
    buffer_load_dwordx4 v214, s[52:55], s68 offen offset:0 lds
    s_lshr_b32 s59, s2, 6
    s_add_u32 s59, s59, s62
    s_lshl_b32 s59, s59, 1
    s_add_u32 s59, s59, s81
    s_bfe_u32 s3, s2, 0x30003
    s_mul_i32 s96, s56, 40960
    s_lshl_b32 s60, s88, 13
    v_and_b32 v60, 31, v1
    v_lshlrev_b32 v60, 7, v60
    v_add_u32 v60, s60, v60
    v_bfe_u32 v61, v1, 1, 3
    v_lshrrev_b32 v192, 5, v1
    v_xor_b32 v61, v61, v192
    buffer_load_dwordx4 v215, s[52:55], s68 offen offset:1024 lds
    v_lshlrev_b32 v61, 4, v61
    v_xor_b32 v192, 0, v61
    v_add_u32 v192, v192, v60
    v_xor_b32 v193, 32, v61
    v_add_u32 v193, v193, v60
    v_xor_b32 v194, 64, v61
    v_add_u32 v194, v194, v60
    v_xor_b32 v195, 96, v61
    v_add_u32 v195, v195, v60
    s_lshl_b32 s60, s89, 12
    s_add_u32 s60, s60, 49152
    v_and_b32 v60, 31, v1
    buffer_load_dwordx4 v216, s[52:55], s68 offen offset:2048 lds
    s_add_u32 m0, s75, 16384
    s_add_u32 s68, s79, 1
    s_and_b32 s68, s68, 7
    s_mul_i32 s68, s68, 128
    s_add_u32 s68, s68, s73
    v_lshlrev_b32 v60, 7, v60
    v_add_u32 v60, s60, v60
    v_bfe_u32 v61, v1, 1, 3
    v_lshrrev_b32 v196, 5, v1
    v_xor_b32 v61, v61, v196
    v_lshlrev_b32 v61, 4, v61
    v_xor_b32 v196, 0, v61
    v_add_u32 v196, v196, v60
    v_xor_b32 v197, 32, v61
    v_add_u32 v197, v197, v60
    v_xor_b32 v198, 64, v61
    v_add_u32 v198, v198, v60
    v_xor_b32 v199, 96, v61
    buffer_load_dwordx4 v206, s[4:7], s68 offen offset:0 lds
    v_add_u32 v199, v199, v60
    v_lshrrev_b32 v60, 5, v1
    v_bfe_u32 v61, v1, 2, 2
    v_lshl_add_u32 v60, v60, 3, v61
    v_mul_u32_u24 v60, 192, v60
    v_bfe_u32 v61, v1, 4, 1
    v_lshl_add_u32 v60, v61, 5, v60
    v_and_b32 v61, 1, v1
    v_lshl_add_u32 v60, v61, 4, v60
    v_bfe_u32 v61, v1, 1, 1
    v_lshl_add_u32 v60, v61, 3, v60
    v_add_u32 v204, 98304, v60
    buffer_load_dwordx4 v207, s[4:7], s68 offen offset:1024 lds
    v_bfe_u32 v60, v1, 3, 1
    v_lshlrev_b32 v61, 12, v60
    v_xor_b32 v60, s88, v60
    v_lshlrev_b32 v60, 1, v60
    v_bfe_u32 v62, v1, 1, 2
    v_lshl_add_u32 v61, v62, 10, v61
    v_and_b32 v62, 1, v62
    v_lshl_add_u32 v60, v62, 2, v60
    v_and_b32 v62, 1, v1
    v_lshl_add_u32 v61, v62, 8, v61
    v_or_b32 v60, v60, v62
    v_bfe_u32 v62, v1, 4, 1
    v_lshl_add_u32 v61, v62, 7, v61
    buffer_load_dwordx4 v208, s[4:7], s68 offen offset:2048 lds
    s_lshl_b32 s60, s89, 13
    s_lshl_b32 s61, s88, 9
    s_add_u32 s60, s60, s61
    v_add_u32 v61, s60, v61
    v_lshrrev_b32 v62, 5, v1
    v_xor_b32 v60, v60, v62
    v_lshlrev_b32 v60, 4, v60
    v_xor_b32 v200, 0, v60
    v_add_u32 v200, v200, v61
    v_xor_b32 v201, 32, v60
    v_add_u32 v201, v201, v61
    v_xor_b32 v202, 64, v60
    buffer_load_dwordx4 v209, s[4:7], s68 offen offset:3072 lds
    s_add_u32 m0, s75, 65536
    s_add_u32 s68, s79, 1
    s_and_b32 s68, s68, 7
    s_mul_i32 s68, s68, 128
    s_add_u32 s68, s68, s74
    v_add_u32 v202, v202, v61
    v_xor_b32 v203, 96, v60
    v_add_u32 v203, v203, v61
    v_lshrrev_b32 v60, 3, v1
    v_mul_u32_u24 v60, 4096, v60
    v_and_b32 v61, 7, v1
    v_lshrrev_b32 v240, 4, v1
    v_xor_b32 v61, v61, v240
    v_lshlrev_b32 v61, 4, v61
    v_add_u32 v240, v61, v60
    v_xor_b32 v61, 64, v61
    v_add_u32 v241, v61, v60
    v_add_u32 v242, 63488, v240
    buffer_load_dwordx4 v210, s[8:11], s68 offen offset:0 lds
    v_add_u32 v243, 95232, v241
    v_add_u32 v241, 31744, v241
    s_lshl_b32 s60, s81, 12
    v_and_b32 v60, 31, v1
    v_lshlrev_b32 v60, 7, v60
    v_add_u32 v60, s60, v60
    v_bfe_u32 v61, v1, 1, 3
    v_lshrrev_b32 v244, 5, v1
    v_xor_b32 v61, v61, v244
    v_lshlrev_b32 v61, 4, v61
    v_xor_b32 v244, 0, v61
    v_add_u32 v244, v244, v60
    buffer_load_dwordx4 v211, s[8:11], s68 offen offset:1024 lds
    v_xor_b32 v245, 32, v61
    v_add_u32 v245, v245, v60
    v_xor_b32 v246, 64, v61
    v_add_u32 v246, v246, v60
    v_xor_b32 v247, 96, v61
    v_add_u32 v247, v247, v60
    s_lshr_b32 s69, s59, 1
    s_lshl_b32 s69, s69, 19
    s_and_b32 s61, s56, 1
    s_lshl_b32 s61, s61, 18
    s_add_u32 s69, s69, s61
    s_lshl_b32 s61, s81, 11
    s_add_u32 s69, s69, s61
    buffer_load_dwordx4 v212, s[8:11], s68 offen offset:2048 lds
    s_lshr_b32 s61, s56, 1
    s_lshl_b32 s61, s61, 10
    s_add_u32 s69, s69, s61
    s_lshl_b32 s91, s88, 13
    s_mul_i32 s60, s89, 49152
    s_add_u32 s91, s91, s60
    s_add_u32 s90, s91, 32768
    s_add_u32 s92, s91, 16384
    s_lshl_b32 s60, s56, 13
    s_add_u32 s93, s60, 106496
    s_add_u32 s94, s60, 139264
    s_cmp_eq_u32 s56, 3
    s_cselect_b32 s94, 98304, s94
    buffer_load_dwordx4 v213, s[8:11], s68 offen offset:3072 lds
    s_lshl_b32 s63, s57, 1
    s_add_u32 s63, s63, s88
    s_lshl_b32 s60, s58, 1
    s_add_u32 s60, s60, s89
    s_lshl_b32 s97, s63, 4
    s_add_u32 s97, s97, s60
    s_lshl_b32 s60, s60, 5
    v_and_b32 v60, 31, v1
    v_add_lshl_u32 v60, v60, s60, 1
    s_waitcnt lgkmcnt(0)
    global_load_ushort v228, v60, s[36:37]
    global_load_ushort v229, v60, s[38:39]
    global_load_ushort v230, v60, s[40:41]
    s_waitcnt lgkmcnt(0)
    s_cmp_lg_u32 s56, 0
    s_cbranch_scc1 .Lc2_5
    s_getpc_b64 s[64:65]
.Lpc_6:
    s_sub_u32 s64, s64, .Lpc_6-gated_mix__ssm_conv_s5__mixer_gmlp__prompt_kernel
    s_subb_u32 s65, s65, 0
    v_add_u32 v4, 32768, v4
    v_min_u32 v4, .Lend_1-gated_mix__ssm_conv_s5__mixer_gmlp__prompt_kernel, v4
    global_load_dword v5, v4, s[64:65]
.Lc2_5:
    s_load_dword s100, s[16:17], 0
    s_waitcnt lgkmcnt(0)
    s_mul_i32 s100, s100, 0x9E3779B1
    s_add_u32 s100, s100, 0x7F4A7C15
    s_waitcnt vmcnt(14)
    s_barrier
    ds_read_b128 v[128:131], v192 offset:0
    ds_read_b128 v[144:147], v196 offset:0
    ds_read_b128 v[132:135], v193 offset:4096
    ds_read_b128 v[148:151], v196 offset:8192
    ds_read_b128 v[184:187], v200 offset:0
    ds_read_b64_tr_b16 v[160:161], v204 offset:0
    ds_read_b64_tr_b16 v[162:163], v204 offset:768
    ds_read_b64_tr_b16 v[164:165], v204 offset:64
    ds_read_b64_tr_b16 v[166:167], v204 offset:832
    ds_read_b64_tr_b16 v[168:169], v204 offset:128
    ds_read_b64_tr_b16 v[170:171], v204 offset:896
    s_waitcnt lgkmcnt(7)
    v_mfma_f32_32x32x16_bf16 v[16:31], v[128:131], v[144:147], 0
    ds_read_b128 v[136:139], v193 offset:0
    ds_read_b128 v[152:155], v197 offset:0
    v_mfma_f32_32x32x16_bf16 v[48:63], v[132:135], v[144:147], 0
    ds_read_b128 v[140:143], v192 offset:4096
    ds_read_b128 v[156:159], v197 offset:8192
    v_mfma_f32_32x32x16_bf16 v[64:79], v[132:135], v[148:151], 0
    ds_read_b128 v[188:191], v201 offset:0
    ds_read_b64_tr_b16 v[172:173], v204 offset:3072
    v_mfma_f32_32x32x16_bf16 v[32:47], v[128:131], v[148:151], 0
    ds_read_b64_tr_b16 v[174:175], v204 offset:3840
    ds_read_b64_tr_b16 v[176:177], v204 offset:3136
    s_add_u32 m0, s76, 24576
    s_add_u32 s68, s79, 2
    s_and_b32 s68, s68, 7
    s_mul_i32 s68, s68, 176128
    s_add_u32 s68, s68, s78
    s_waitcnt lgkmcnt(8)
    v_mfma_f32_32x32x16_bf16 v[80:95], v[160:163], v[184:187], 0
    ds_read_b64_tr_b16 v[178:179], v204 offset:3904
    buffer_load_dwordx4 v214, s[52:55], s68 offen offset:0 lds
    ds_read_b64_tr_b16 v[180:181], v204 offset:3200
    ds_read_b64_tr_b16 v[182:183], v204 offset:3968
    buffer_load_dwordx4 v215, s[52:55], s68 offen offset:1024 lds
    v_mfma_f32_32x32x16_bf16 v[96:111], v[164:167], v[184:187], 0
    v_mfma_f32_32x32x16_bf16 v[112:127], v[168:171], v[184:187], 0
    buffer_load_dwordx4 v216, s[52:55], s68 offen offset:2048 lds
    s_add_u32 m0, s75, 32768
    s_add_u32 s68, s79, 2
    s_and_b32 s68, s68, 7
    s_mul_i32 s68, s68, 128
    s_add_u32 s68, s68, s73
    s_waitcnt lgkmcnt(7)
    v_mfma_f32_32x32x16_bf16 v[16:31], v[136:139], v[152:155], v[16:31]
    ds_read_b128 v[128:131], v194 offset:0
    ds_read_b128 v[144:147], v198 offset:0
    v_mfma_f32_32x32x16_bf16 v[48:63], v[140:143], v[152:155], v[48:63]
    ds_read_b128 v[132:135], v195 offset:4096
    ds_read_b128 v[148:151], v198 offset:8192
    v_mfma_f32_32x32x16_bf16 v[64:79], v[140:143], v[156:159], v[64:79]
    ds_read_b128 v[184:187], v202 offset:0
    ds_read_b64_tr_b16 v[160:161], v204 offset:6144
    v_mfma_f32_32x32x16_bf16 v[32:47], v[136:139], v[156:159], v[32:47]
    ds_read_b64_tr_b16 v[162:163], v204 offset:6912
    ds_read_b64_tr_b16 v[164:165], v204 offset:6208
    buffer_load_dwordx4 v206, s[4:7], s68 offen offset:0 lds
    s_waitcnt lgkmcnt(8)
    v_mfma_f32_32x32x16_bf16 v[80:95], v[172:175], v[188:191], v[80:95]
    ds_read_b64_tr_b16 v[166:167], v204 offset:6976
    buffer_load_dwordx4 v207, s[4:7], s68 offen offset:1024 lds
    ds_read_b64_tr_b16 v[168:169], v204 offset:6272
    ds_read_b64_tr_b16 v[170:171], v204 offset:7040
    buffer_load_dwordx4 v208, s[4:7], s68 offen offset:2048 lds
    v_mfma_f32_32x32x16_bf16 v[96:111], v[176:179], v[188:191], v[96:111]
    v_mfma_f32_32x32x16_bf16 v[112:127], v[180:183], v[188:191], v[112:127]
    buffer_load_dwordx4 v209, s[4:7], s68 offen offset:3072 lds
    s_add_u32 m0, s75, 81920
    s_add_u32 s68, s79, 2
    s_and_b32 s68, s68, 7
    s_mul_i32 s68, s68, 128
    s_add_u32 s68, s68, s74
    s_waitcnt lgkmcnt(7)
    v_mfma_f32_32x32x16_bf16 v[16:31], v[128:131], v[144:147], v[16:31]
    ds_read_b128 v[136:139], v195 offset:0
    ds_read_b128 v[152:155], v199 offset:0
    v_mfma_f32_32x32x16_bf16 v[48:63], v[132:135], v[144:147], v[48:63]
    ds_read_b128 v[140:143], v194 offset:4096
    ds_read_b128 v[156:159], v199 offset:8192
    v_mfma_f32_32x32x16_bf16 v[64:79], v[132:135], v[148:151], v[64:79]
    ds_read_b128 v[188:191], v203 offset:0
    ds_read_b64_tr_b16 v[172:173], v204 offset:9216
    v_mfma_f32_32x32x16_bf16 v[32:47], v[128:131], v[148:151], v[32:47]
    ds_read_b64_tr_b16 v[174:175], v204 offset:9984
    ds_read_b64_tr_b16 v[176:177], v204 offset:9280
    buffer_load_dwordx4 v210, s[8:11], s68 offen offset:0 lds
    s_waitcnt lgkmcnt(8)
    v_mfma_f32_32x32x16_bf16 v[80:95], v[160:163], v[184:187], v[80:95]
    ds_read_b64_tr_b16 v[178:179], v204 offset:10048
    buffer_load_dwordx4 v211, s[8:11], s68 offen offset:1024 lds
    ds_read_b64_tr_b16 v[180:181], v204 offset:9344
    ds_read_b64_tr_b16 v[182:183], v204 offset:10112
    buffer_load_dwordx4 v212, s[8:11], s68 offen offset:2048 lds
    v_mfma_f32_32x32x16_bf16 v[96:111], v[164:167], v[184:187], v[96:111]
    v_mfma_f32_32x32x16_bf16 v[112:127], v[168:171], v[184:187], v[112:127]
    buffer_load_dwordx4 v213, s[8:11], s68 offen offset:3072 lds
    s_waitcnt vmcnt(14) lgkmcnt(0)
    s_barrier
    v_mfma_f32_32x32x16_bf16 v[16:31], v[136:139], v[152:155], v[16:31]
    ds_read_b128 v[128:131], v192 offset:16384
    ds_read_b128 v[144:147], v196 offset:16384
    v_mfma_f32_32x32x16_bf16 v[48:63], v[140:143], v[152:155], v[48:63]
    ds_read_b128 v[132:135], v193 offset:20480
    ds_read_b128 v[148:151], v196 offset:24576
    v_mfma_f32_32x32x16_bf16 v[64:79], v[140:143], v[156:159], v[64:79]
    ds_read_b128 v[184:187], v200 offset:16384
    ds_read_b64_tr_b16 v[160:161], v204 offset:12288
    v_mfma_f32_32x32x16_bf16 v[32:47], v[136:139], v[156:159], v[32:47]
    ds_read_b64_tr_b16 v[162:163], v204 offset:13056
    ds_read_b64_tr_b16 v[164:165], v204 offset:12352
    s_add_u32 m0, s76, 0
    s_add_u32 s68, s79, 3
    s_and_b32 s68, s68, 7
    s_mul_i32 s68, s68, 176128
    s_add_u32 s68, s68, s78
    v_mfma_f32_32x32x16_bf16 v[80:95], v[172:175], v[188:191], v[80:95]
    ds_read_b64_tr_b16 v[166:167], v204 offset:13120
    ds_read_b64_tr_b16 v[168:169], v204 offset:12416
    buffer_load_dwordx4 v214, s[52:55], s68 offen offset:0 lds
    ds_read_b64_tr_b16 v[170:171], v204 offset:13184
    v_mfma_f32_32x32x16_bf16 v[96:111], v[176:179], v[188:191], v[96:111]
    v_mfma_f32_32x32x16_bf16 v[112:127], v[180:183], v[188:191], v[112:127]
    buffer_load_dwordx4 v215, s[52:55], s68 offen offset:1024 lds
    s_waitcnt lgkmcnt(7)
    v_mfma_f32_32x32x16_bf16 v[16:31], v[128:131], v[144:147], v[16:31]
    ds_read_b128 v[136:139], v193 offset:16384
    ds_read_b128 v[152:155], v197 offset:16384
    v_mfma_f32_32x32x16_bf16 v[48:63], v[132:135], v[144:147], v[48:63]
    ds_read_b128 v[140:143], v192 offset:20480
    ds_read_b128 v[156:159], v197 offset:24576
    v_mfma_f32_32x32x16_bf16 v[64:79], v[132:135], v[148:151], v[64:79]
    ds_read_b128 v[188:191], v201 offset:16384
    ds_read_b64_tr_b16 v[172:173], v204 offset:15360
    v_mfma_f32_32x32x16_bf16 v[32:47], v[128:131], v[148:151], v[32:47]
    ds_read_b64_tr_b16 v[174:175], v204 offset:16128
    ds_read_b64_tr_b16 v[176:177], v204 offset:15424
    buffer_load_dwordx4 v216, s[52:55], s68 offen offset:2048 lds
    s_add_u32 m0, s75, 0
    s_add_u32 s68, s79, 3
    s_and_b32 s68, s68, 7
    s_mul_i32 s68, s68, 128
    s_add_u32 s68, s68, s73
    s_waitcnt lgkmcnt(8)
    v_mfma_f32_32x32x16_bf16 v[80:95], v[160:163], v[184:187], v[80:95]
    ds_read_b64_tr_b16 v[178:179], v204 offset:16192
    ds_read_b64_tr_b16 v[180:181], v204 offset:15488
    buffer_load_dwordx4 v206, s[4:7], s68 offen offset:0 lds
    ds_read_b64_tr_b16 v[182:183], v204 offset:16256
    v_mfma_f32_32x32x16_bf16 v[96:111], v[164:167], v[184:187], v[96:111]
    v_mfma_f32_32x32x16_bf16 v[112:127], v[168:171], v[184:187], v[112:127]
    buffer_load_dwordx4 v207, s[4:7], s68 offen offset:1024 lds
    s_waitcnt lgkmcnt(7)
    v_mfma_f32_32x32x16_bf16 v[16:31], v[136:139], v[152:155], v[16:31]
    ds_read_b128 v[128:131], v194 offset:16384
    ds_read_b128 v[144:147], v198 offset:16384
    v_mfma_f32_32x32x16_bf16 v[48:63], v[140:143], v[152:155], v[48:63]
    ds_read_b128 v[132:135], v195 offset:20480
    ds_read_b128 v[148:151], v198 offset:24576
    v_mfma_f32_32x32x16_bf16 v[64:79], v[140:143], v[156:159], v[64:79]
    ds_read_b128 v[184:187], v202 offset:16384
    ds_read_b64_tr_b16 v[160:161], v204 offset:18432
    v_mfma_f32_32x32x16_bf16 v[32:47], v[136:139], v[156:159], v[32:47]
    ds_read_b64_tr_b16 v[162:163], v204 offset:19200
    ds_read_b64_tr_b16 v[164:165], v204 offset:18496
    buffer_load_dwordx4 v208, s[4:7], s68 offen offset:2048 lds
    s_waitcnt lgkmcnt(8)
    v_mfma_f32_32x32x16_bf16 v[80:95], v[172:175], v[188:191], v[80:95]
    ds_read_b64_tr_b16 v[166:167], v204 offset:19264
    ds_read_b64_tr_b16 v[168:169], v204 offset:18560
    buffer_load_dwordx4 v209, s[4:7], s68 offen offset:3072 lds
    s_add_u32 m0, s75, 49152
    s_add_u32 s68, s79, 3
    s_and_b32 s68, s68, 7
    s_mul_i32 s68, s68, 128
    s_add_u32 s68, s68, s74
    ds_read_b64_tr_b16 v[170:171], v204 offset:19328
    v_mfma_f32_32x32x16_bf16 v[96:111], v[176:179], v[188:191], v[96:111]
    v_mfma_f32_32x32x16_bf16 v[112:127], v[180:183], v[188:191], v[112:127]
    buffer_load_dwordx4 v210, s[8:11], s68 offen offset:0 lds
    s_waitcnt lgkmcnt(7)
    v_mfma_f32_32x32x16_bf16 v[16:31], v[128:131], v[144:147], v[16:31]
    ds_read_b128 v[136:139], v195 offset:16384
    ds_read_b128 v[152:155], v199 offset:16384
    v_mfma_f32_32x32x16_bf16 v[48:63], v[132:135], v[144:147], v[48:63]
    ds_read_b128 v[140:143], v194 offset:20480
    ds_read_b128 v[156:159], v199 offset:24576
    v_mfma_f32_32x32x16_bf16 v[64:79], v[132:135], v[148:151], v[64:79]
    ds_read_b128 v[188:191], v203 offset:16384
    ds_read_b64_tr_b16 v[172:173], v204 offset:21504
    v_mfma_f32_32x32x16_bf16 v[32:47], v[128:131], v[148:151], v[32:47]
    ds_read_b64_tr_b16 v[174:175], v204 offset:22272
    ds_read_b64_tr_b16 v[176:177], v204 offset:21568
    buffer_load_dwordx4 v211, s[8:11], s68 offen offset:1024 lds
    s_waitcnt lgkmcnt(8)
    v_mfma_f32_32x32x16_bf16 v[80:95], v[160:163], v[184:187], v[80:95]
    ds_read_b64_tr_b16 v[178:179], v204 offset:22336
    ds_read_b64_tr_b16 v[180:181], v204 offset:21632
    buffer_load_dwordx4 v212, s[8:11], s68 offen offset:2048 lds
    ds_read_b64_tr_b16 v[182:183], v204 offset:22400
    v_mfma_f32_32x32x16_bf16 v[96:111], v[164:167], v[184:187], v[96:111]
    v_mfma_f32_32x32x16_bf16 v[112:127], v[168:171], v[184:187], v[112:127]
    buffer_load_dwordx4 v213, s[8:11], s68 offen offset:3072 lds
    s_waitcnt vmcnt(11) lgkmcnt(0)
    s_barrier
    v_mfma_f32_32x32x16_bf16 v[16:31], v[136:139], v[152:155], v[16:31]
    ds_read_b128 v[128:131], v192 offset:32768
    ds_read_b128 v[144:147], v196 offset:32768
    v_mfma_f32_32x32x16_bf16 v[48:63], v[140:143], v[152:155], v[48:63]
    ds_read_b128 v[132:135], v193 offset:36864
    ds_read_b128 v[148:151], v196 offset:40960
    v_mfma_f32_32x32x16_bf16 v[64:79], v[140:143], v[156:159], v[64:79]
    ds_read_b128 v[184:187], v200 offset:32768
    ds_read_b64_tr_b16 v[160:161], v204 offset:24576
    v_mfma_f32_32x32x16_bf16 v[32:47], v[136:139], v[156:159], v[32:47]
    ds_read_b64_tr_b16 v[162:163], v204 offset:25344
    ds_read_b64_tr_b16 v[164:165], v204 offset:24640
    s_add_u32 m0, s76, 12288
    s_add_u32 s68, s79, 4
    s_and_b32 s68, s68, 7
    s_mul_i32 s68, s68, 176128
    s_add_u32 s68, s68, s78
    v_mfma_f32_32x32x16_bf16 v[80:95], v[172:175], v[188:191], v[80:95]
    ds_read_b64_tr_b16 v[166:167], v204 offset:25408
    ds_read_b64_tr_b16 v[168:169], v204 offset:24704
    buffer_load_dwordx4 v214, s[52:55], s68 offen offset:0 lds
    ds_read_b64_tr_b16 v[170:171], v204 offset:25472
    v_mfma_f32_32x32x16_bf16 v[96:111], v[176:179], v[188:191], v[96:111]
    v_mfma_f32_32x32x16_bf16 v[112:127], v[180:183], v[188:191], v[112:127]
    buffer_load_dwordx4 v215, s[52:55], s68 offen offset:1024 lds
    s_waitcnt lgkmcnt(7)
    v_mfma_f32_32x32x16_bf16 v[16:31], v[128:131], v[144:147], v[16:31]
    ds_read_b128 v[136:139], v193 offset:32768
    ds_read_b128 v[152:155], v197 offset:32768
    v_mfma_f32_32x32x16_bf16 v[48:63], v[132:135], v[144:147], v[48:63]
    ds_read_b128 v[140:143], v192 offset:36864
    ds_read_b128 v[156:159], v197 offset:40960
    v_mfma_f32_32x32x16_bf16 v[64:79], v[132:135], v[148:151], v[64:79]
    ds_read_b128 v[188:191], v201 offset:32768
    ds_read_b64_tr_b16 v[172:173], v204 offset:27648
    v_lshlrev_b32 v228, 16, v228
    v_mfma_f32_32x32x16_bf16 v[32:47], v[128:131], v[148:151], v[32:47]
    ds_read_b64_tr_b16 v[174:175], v204 offset:28416
    ds_read_b64_tr_b16 v[176:177], v204 offset:27712
    buffer_load_dwordx4 v216, s[52:55], s68 offen offset:2048 lds
    s_add_u32 m0, s75, 16384
    s_add_u32 s68, s79, 4
    s_and_b32 s68, s68, 7
    s_mul_i32 s68, s68, 128
    s_add_u32 s68, s68, s73
    v_lshlrev_b32 v229, 16, v229
    s_waitcnt lgkmcnt(8)
    v_mfma_f32_32x32x16_bf16 v[80:95], v[160:163], v[184:187], v[80:95]
    ds_read_b64_tr_b16 v[178:179], v204 offset:28480
    ds_read_b64_tr_b16 v[180:181], v204 offset:27776
    buffer_load_dwordx4 v206, s[4:7], s68 offen offset:0 lds
    v_lshlrev_b32 v230, 16, v230
    ds_read_b64_tr_b16 v[182:183], v204 offset:28544
    v_mfma_f32_32x32x16_bf16 v[96:111], v[164:167], v[184:187], v[96:111]
    v_mfma_f32_32x32x16_bf16 v[112:127], v[168:171], v[184:187], v[112:127]
    buffer_load_dwordx4 v207, s[4:7], s68 offen offset:1024 lds
    v_mul_f32 v232, 1069066811, v230
    s_waitcnt lgkmcnt(7)
    v_mfma_f32_32x32x16_bf16 v[16:31], v[136:139], v[152:155], v[16:31]
    ds_read_b128 v[128:131], v194 offset:32768
    ds_read_b128 v[144:147], v198 offset:32768
    v_mfma_f32_32x32x16_bf16 v[48:63], v[140:143], v[152:155], v[48:63]
    ds_read_b128 v[132:135], v195 offset:36864
    v_exp_f32 v232, v232
    ds_read_b128 v[148:151], v198 offset:40960
    v_mfma_f32_32x32x16_bf16 v[64:79], v[140:143], v[156:159], v[64:79]
    ds_read_b128 v[184:187], v202 offset:32768
    ds_read_b64_tr_b16 v[160:161], v204 offset:30720
    v_cvt_pk_bf16_f32 v232, v232, v232
    v_mfma_f32_32x32x16_bf16 v[32:47], v[136:139], v[156:159], v[32:47]
    ds_read_b64_tr_b16 v[162:163], v204 offset:31488
    ds_read_b64_tr_b16 v[164:165], v204 offset:30784
    buffer_load_dwordx4 v208, s[4:7], s68 offen offset:2048 lds
    v_lshlrev_b32 v232, 16, v232
    s_waitcnt lgkmcnt(8)
    v_mfma_f32_32x32x16_bf16 v[80:95], v[172:175], v[188:191], v[80:95]
    ds_read_b64_tr_b16 v[166:167], v204 offset:31552
    ds_read_b64_tr_b16 v[168:169], v204 offset:30848
    buffer_load_dwordx4 v209, s[4:7], s68 offen offset:3072 lds
    s_add_u32 m0, s75, 65536
    s_add_u32 s68, s79, 4
    s_and_b32 s68, s68, 7
    s_mul_i32 s68, s68, 128
    s_add_u32 s68, s68, s74
    v_mul_f32 v233, v232, v228
    ds_read_b64_tr_b16 v[170:171], v204 offset:31616
    v_mfma_f32_32x32x16_bf16 v[96:111], v[176:179], v[188:191], v[96:111]
    v_mfma_f32_32x32x16_bf16 v[112:127], v[180:183], v[188:191], v[112:127]
    buffer_load_dwordx4 v210, s[8:11], s68 offen offset:0 lds
    v_mul_f32 v234, v232, v229
    s_waitcnt lgkmcnt(7)
    v_mfma_f32_32x32x16_bf16 v[16:31], v[128:131], v[144:147], v[16:31]
    ds_read_b128 v[136:139], v195 offset:32768
    ds_read_b128 v[152:155], v199 offset:32768
    v_mfma_f32_32x32x16_bf16 v[48:63], v[132:135], v[144:147], v[48:63]
    ds_read_b128 v[140:143], v194 offset:36864
    v_mul_f32 v233, 1069066811, v233
    ds_read_b128 v[156:159], v199 offset:40960
    v_mfma_f32_32x32x16_bf16 v[64:79], v[132:135], v[148:151], v[64:79]
    ds_read_b128 v[188:191], v203 offset:32768
    ds_read_b64_tr_b16 v[172:173], v204 offset:33792
    v_exp_f32 v233, v233
    v_mfma_f32_32x32x16_bf16 v[32:47], v[128:131], v[148:151], v[32:47]
    ds_read_b64_tr_b16 v[174:175], v204 offset:34560
    ds_read_b64_tr_b16 v[176:177], v204 offset:33856
    buffer_load_dwordx4 v211, s[8:11], s68 offen offset:1024 lds
    v_mul_f32 v234, 1042479491, v234
    s_waitcnt lgkmcnt(8)
    v_mfma_f32_32x32x16_bf16 v[80:95], v[160:163], v[184:187], v[80:95]
    ds_read_b64_tr_b16 v[178:179], v204 offset:34624
    ds_read_b64_tr_b16 v[180:181], v204 offset:33920
    buffer_load_dwordx4 v212, s[8:11], s68 offen offset:2048 lds
    v_fract_f32 v234, v234
    ds_read_b64_tr_b16 v[182:183], v204 offset:34688
    v_mfma_f32_32x32x16_bf16 v[96:111], v[164:167], v[184:187], v[96:111]
    v_mfma_f32_32x32x16_bf16 v[112:127], v[168:171], v[184:187], v[112:127]
    buffer_load_dwordx4 v213, s[8:11], s68 offen offset:3072 lds
    v_cos_f32 v235, v234
    s_waitcnt vmcnt(11) lgkmcnt(0)
    s_barrier
    v_mfma_f32_32x32x16_bf16 v[16:31], v[136:139], v[152:155], v[16:31]
    ds_read_b128 v[128:131], v192 offset:0
    ds_read_b128 v[144:147], v196 offset:0
    v_mfma_f32_32x32x16_bf16 v[48:63], v[140:143], v[152:155], v[48:63]
    ds_read_b128 v[132:135], v193 offset:4096
    v_sin_f32 v234, v234
    ds_read_b128 v[148:151], v196 offset:8192
    v_mfma_f32_32x32x16_bf16 v[64:79], v[140:143], v[156:159], v[64:79]
    ds_read_b128 v[184:187], v200 offset:0
    ds_read_b64_tr_b16 v[160:161], v204 offset:0
    v_mul_f32 v232, v228, v228
    v_mfma_f32_32x32x16_bf16 v[32:47], v[136:139], v[156:159], v[32:47]
    ds_read_b64_tr_b16 v[162:163], v204 offset:768
    ds_read_b64_tr_b16 v[164:165], v204 offset:64
    s_add_u32 m0, s76, 24576
    s_add_u32 s68, s79, 5
    s_and_b32 s68, s68, 7
    s_mul_i32 s68, s68, 176128
    s_add_u32 s68, s68, s78
    v_mul_f32 v218, v233, v235
    v_mfma_f32_32x32x16_bf16 v[80:95], v[172:175], v[188:191], v[80:95]
    ds_read_b64_tr_b16 v[166:167], v204 offset:832
    ds_read_b64_tr_b16 v[168:169], v204 offset:128
    buffer_load_dwordx4 v214, s[52:55], s68 offen offset:0 lds
    v_mul_f32 v219, v233, v234
    ds_read_b64_tr_b16 v[170:171], v204 offset:896
    v_mfma_f32_32x32x16_bf16 v[96:111], v[176:179], v[188:191], v[96:111]
    v_mfma_f32_32x32x16_bf16 v[112:127], v[180:183], v[188:191], v[112:127]
    buffer_load_dwordx4 v215, s[52:55], s68 offen offset:1024 lds
    v_fmac_f32 v232, v229, v229
    s_waitcnt lgkmcnt(7)
    v_mfma_f32_32x32x16_bf16 v[16:31], v[128:131], v[144:147], v[16:31]
    ds_read_b128 v[136:139], v193 offset:0
    ds_read_b128 v[152:155], v197 offset:0
    v_mfma_f32_32x32x16_bf16 v[48:63], v[132:135], v[144:147], v[48:63]
    ds_read_b128 v[140:143], v192 offset:4096
    v_rcp_f32 v232, v232
    ds_read_b128 v[156:159], v197 offset:8192
    v_mfma_f32_32x32x16_bf16 v[64:79], v[132:135], v[148:151], v[64:79]
    ds_read_b128 v[188:191], v201 offset:0
    ds_read_b64_tr_b16 v[172:173], v204 offset:3072
    v_add_f32 v233, -1.0, v218
    v_mfma_f32_32x32x16_bf16 v[32:47], v[128:131], v[148:151], v[32:47]
    ds_read_b64_tr_b16 v[174:175], v204 offset:3840
    ds_read_b64_tr_b16 v[176:177], v204 offset:3136
    buffer_load_dwordx4 v216, s[52:55], s68 offen offset:2048 lds
    s_add_u32 m0, s75, 32768
    s_add_u32 s68, s79, 5
    s_and_b32 s68, s68, 7
    s_mul_i32 s68, s68, 128
    s_add_u32 s68, s68, s73
    v_add_f32 v232, v232, v232
    s_waitcnt lgkmcnt(8)
    v_mfma_f32_32x32x16_bf16 v[80:95], v[160:163], v[184:187], v[80:95]
    ds_read_b64_tr_b16 v[178:179], v204 offset:3904
    ds_read_b64_tr_b16 v[180:181], v204 offset:3200
    buffer_load_dwordx4 v206, s[4:7], s68 offen offset:0 lds
    v_mul_f32 v234, v233, v228
    ds_read_b64_tr_b16 v[182:183], v204 offset:3968
    v_mfma_f32_32x32x16_bf16 v[96:111], v[164:167], v[184:187], v[96:111]
    v_mfma_f32_32x32x16_bf16 v[112:127], v[168:171], v[184:187], v[112:127]
    buffer_load_dwordx4 v207, s[4:7], s68 offen offset:1024 lds
    v_fmac_f32 v234, v219, v229
    s_waitcnt lgkmcnt(7)
    v_mfma_f32_32x32x16_bf16 v[16:31], v[136:139], v[152:155], v[16:31]
    ds_read_b128 v[128:131], v194 offset:0
    ds_read_b128 v[144:147], v198 offset:0
    v_mfma_f32_32x32x16_bf16 v[48:63], v[140:143], v[152:155], v[48:63]
    ds_read_b128 v[132:135], v195 offset:4096
    v_mul_f32 v220, v234, v232
    ds_read_b128 v[148:151], v198 offset:8192
    v_mfma_f32_32x32x16_bf16 v[64:79], v[140:143], v[156:159], v[64:79]
    ds_read_b128 v[184:187], v202 offset:0
    ds_read_b64_tr_b16 v[160:161], v204 offset:6144
    v_mul_f32 v234, v219, v228
    v_mfma_f32_32x32x16_bf16 v[32:47], v[136:139], v[156:159], v[32:47]
    ds_read_b64_tr_b16 v[162:163], v204 offset:6912
    ds_read_b64_tr_b16 v[164:165], v204 offset:6208
    buffer_load_dwordx4 v208, s[4:7], s68 offen offset:2048 lds
    v_fma_f32 v234, -v233, v229, v234
    s_waitcnt lgkmcnt(8)
    v_mfma_f32_32x32x16_bf16 v[80:95], v[172:175], v[188:191], v[80:95]
    ds_read_b64_tr_b16 v[166:167], v204 offset:6976
    ds_read_b64_tr_b16 v[168:169], v204 offset:6272
    buffer_load_dwordx4 v209, s[4:7], s68 offen offset:3072 lds
    s_add_u32 m0, s75, 81920
    s_add_u32 s68, s79, 5
    s_and_b32 s68, s68, 7
    s_mul_i32 s68, s68, 128
    s_add_u32 s68, s68, s74
    v_mul_f32 v221, v234, v232
    ds_read_b64_tr_b16 v[170:171], v204 offset:7040
    v_mfma_f32_32x32x16_bf16 v[96:111], v[176:179], v[188:191], v[96:111]
    v_mfma_f32_32x32x16_bf16 v[112:127], v[180:183], v[188:191], v[112:127]
    buffer_load_dwordx4 v210, s[8:11], s68 offen offset:0 lds
    v_mul_f32 v232, v219, v219
    s_waitcnt lgkmcnt(7)
    v_mfma_f32_32x32x16_bf16 v[16:31], v[128:131], v[144:147], v[16:31]
    ds_read_b128 v[136:139], v195 offset:0
    ds_read_b128 v[152:155], v199 offset:0
    v_mfma_f32_32x32x16_bf16 v[48:63], v[132:135], v[144:147], v[48:63]
    ds_read_b128 v[140:143], v194 offset:4096
    v_add_f32 v233, v218, v218
    ds_read_b128 v[156:159], v199 offset:8192
    v_mfma_f32_32x32x16_bf16 v[64:79], v[132:135], v[148:151], v[64:79]
    ds_read_b128 v[188:191], v203 offset:0
    ds_read_b64_tr_b16 v[172:173], v204 offset:9216
    v_mul_f32 v223, v233, v219
    v_mfma_f32_32x32x16_bf16 v[32:47], v[128:131], v[148:151], v[32:47]
    ds_read_b64_tr_b16 v[174:175], v204 offset:9984
    ds_read_b64_tr_b16 v[176:177], v204 offset:9280
    buffer_load_dwordx4 v211, s[8:11], s68 offen offset:1024 lds
    v_fma_f32 v222, v218, v218, -v232
    s_waitcnt lgkmcnt(8)
    v_mfma_f32_32x32x16_bf16 v[80:95], v[160:163], v[184:187], v[80:95]
    ds_read_b64_tr_b16 v[178:179], v204 offset:10048
    ds_read_b64_tr_b16 v[180:181], v204 offset:9344
    buffer_load_dwordx4 v212, s[8:11], s68 offen offset:2048 lds
    v_mul_f32 v232, v223, v223
    ds_read_b64_tr_b16 v[182:183], v204 offset:10112
    v_mfma_f32_32x32x16_bf16 v[96:111], v[164:167], v[184:187], v[96:111]
    v_mfma_f32_32x32x16_bf16 v[112:127], v[168:171], v[184:187], v[112:127]
    buffer_load_dwordx4 v213, s[8:11], s68 offen offset:3072 lds
    v_add_f32 v233, v222, v222
    s_waitcnt vmcnt(11) lgkmcnt(0)
    s_barrier
    v_mfma_f32_32x32x16_bf16 v[16:31], v[136:139], v[152:155], v[16:31]
    ds_read_b128 v[128:131], v192 offset:16384
    ds_read_b128 v[144:147], v196 offset:16384
    v_mfma_f32_32x32x16_bf16 v[48:63], v[140:143], v[152:155], v[48:63]
    ds_read_b128 v[132:135], v193 offset:20480
    v_mul_f32 v223, v233, v223
    ds_read_b128 v[148:151], v196 offset:24576
    v_mfma_f32_32x32x16_bf16 v[64:79], v[140:143], v[156:159], v[64:79]
    ds_read_b128 v[184:187], v200 offset:16384
    ds_read_b64_tr_b16 v[160:161], v204 offset:12288
    v_fma_f32 v222, v222, v222, -v232
    v_mfma_f32_32x32x16_bf16 v[32:47], v[136:139], v[156:159], v[32:47]
    ds_read_b64_tr_b16 v[162:163], v204 offset:13056
    ds_read_b64_tr_b16 v[164:165], v204 offset:12352
    s_add_u32 m0, s76, 0
    s_add_u32 s68, s79, 6
    s_and_b32 s68, s68, 7
    s_mul_i32 s68, s68, 176128
    s_add_u32 s68, s68, s78
    v_mul_f32 v232, v223, v223
    v_mfma_f32_32x32x16_bf16 v[80:95], v[172:175], v[188:191], v[80:95]
    ds_read_b64_tr_b16 v[166:167], v204 offset:13120
    ds_read_b64_tr_b16 v[168:169], v204 offset:12416
    buffer_load_dwordx4 v214, s[52:55], s68 offen offset:0 lds
    v_add_f32 v233, v222, v222
    ds_read_b64_tr_b16 v[170:171], v204 offset:13184
    v_mfma_f32_32x32x16_bf16 v[96:111], v[176:179], v[188:191], v[96:111]
    v_mfma_f32_32x32x16_bf16 v[112:127], v[180:183], v[188:191], v[112:127]
    buffer_load_dwordx4 v215, s[52:55], s68 offen offset:1024 lds
    v_mul_f32 v223, v233, v223
    s_waitcnt lgkmcnt(7)
    v_mfma_f32_32x32x16_bf16 v[16:31], v[128:131], v[144:147], v[16:31]
    ds_read_b128 v[136:139], v193 offset:16384
    ds_read_b128 v[152:155], v197 offset:16384
    v_mfma_f32_32x32x16_bf16 v[48:63], v[132:135], v[144:147], v[48:63]
    ds_read_b128 v[140:143], v192 offset:20480
    v_fma_f32 v222, v222, v222, -v232
    ds_read_b128 v[156:159], v197 offset:24576
    v_mfma_f32_32x32x16_bf16 v[64:79], v[132:135], v[148:151], v[64:79]
    ds_read_b128 v[188:191], v201 offset:16384
    ds_read_b64_tr_b16 v[172:173], v204 offset:15360
    v_mul_f32 v232, v223, v223
    v_mfma_f32_32x32x16_bf16 v[32:47], v[128:131], v[148:151], v[32:47]
    ds_read_b64_tr_b16 v[174:175], v204 offset:16128
    ds_read_b64_tr_b16 v[176:177], v204 offset:15424
    buffer_load_dwordx4 v216, s[52:55], s68 offen offset:2048 lds
    s_add_u32 m0, s75, 0
    s_add_u32 s68, s79, 6
    s_and_b32 s68, s68, 7
    s_mul_i32 s68, s68, 128
    s_add_u32 s68, s68, s73
    v_add_f32 v233, v222, v222
    s_waitcnt lgkmcnt(8)
    v_mfma_f32_32x32x16_bf16 v[80:95], v[160:163], v[184:187], v[80:95]
    ds_read_b64_tr_b16 v[178:179], v204 offset:16192
    ds_read_b64_tr_b16 v[180:181], v204 offset:15488
    buffer_load_dwordx4 v206, s[4:7], s68 offen offset:0 lds
    v_mul_f32 v223, v233, v223
    ds_read_b64_tr_b16 v[182:183], v204 offset:16256
    v_mfma_f32_32x32x16_bf16 v[96:111], v[164:167], v[184:187], v[96:111]
    v_mfma_f32_32x32x16_bf16 v[112:127], v[168:171], v[184:187], v[112:127]
    buffer_load_dwordx4 v207, s[4:7], s68 offen offset:1024 lds
    v_fma_f32 v222, v222, v222, -v232
    s_waitcnt lgkmcnt(7)
    v_mfma_f32_32x32x16_bf16 v[16:31], v[136:139], v[152:155], v[16:31]
    ds_read_b128 v[128:131], v194 offset:16384
    ds_read_b128 v[144:147], v198 offset:16384
    v_mfma_f32_32x32x16_bf16 v[48:63], v[140:143], v[152:155], v[48:63]
    ds_read_b128 v[132:135], v195 offset:20480
    v_mul_f32 v232, v223, v223
    ds_read_b128 v[148:151], v198 offset:24576
    v_mfma_f32_32x32x16_bf16 v[64:79], v[140:143], v[156:159], v[64:79]
    ds_read_b128 v[184:187], v202 offset:16384
    ds_read_b64_tr_b16 v[160:161], v204 offset:18432
    v_add_f32 v233, v222, v222
    v_mfma_f32_32x32x16_bf16 v[32:47], v[136:139], v[156:159], v[32:47]
    ds_read_b64_tr_b16 v[162:163], v204 offset:19200
    ds_read_b64_tr_b16 v[164:165], v204 offset:18496
    buffer_load_dwordx4 v208, s[4:7], s68 offen offset:2048 lds
    v_mul_f32 v237, v233, v223
    s_waitcnt lgkmcnt(8)
    v_mfma_f32_32x32x16_bf16 v[80:95], v[172:175], v[188:191], v[80:95]
    ds_read_b64_tr_b16 v[166:167], v204 offset:19264
    ds_read_b64_tr_b16 v[168:169], v204 offset:18560
    buffer_load_dwordx4 v209, s[4:7], s68 offen offset:3072 lds
    s_add_u32 m0, s75, 49152
    s_add_u32 s68, s79, 6
    s_and_b32 s68, s68, 7
    s_mul_i32 s68, s68, 128
    s_add_u32 s68, s68, s74
    v_fma_f32 v236, v222, v222, -v232
    ds_read_b64_tr_b16 v[170:171], v204 offset:19328
    v_mfma_f32_32x32x16_bf16 v[96:111], v[176:179], v[188:191], v[96:111]
    v_mfma_f32_32x32x16_bf16 v[112:127], v[180:183], v[188:191], v[112:127]
    buffer_load_dwordx4 v210, s[8:11], s68 offen offset:0 lds
    v_mul_f32 v232, v237, v237
    s_waitcnt lgkmcnt(7)
    v_mfma_f32_32x32x16_bf16 v[16:31], v[128:131], v[144:147], v[16:31]
    ds_read_b128 v[136:139], v195 offset:16384
    ds_read_b128 v[152:155], v199 offset:16384
    v_mfma_f32_32x32x16_bf16 v[48:63], v[132:135], v[144:147], v[48:63]
    ds_read_b128 v[140:143], v194 offset:20480
    v_add_f32 v233, v236, v236
    ds_read_b128 v[156:159], v199 offset:24576
    v_mfma_f32_32x32x16_bf16 v[64:79], v[132:135], v[148:151], v[64:79]
    ds_read_b128 v[188:191], v203 offset:16384
    ds_read_b64_tr_b16 v[172:173], v204 offset:21504
    v_mul_f32 v239, v233, v237
    v_mfma_f32_32x32x16_bf16 v[32:47], v[128:131], v[148:151], v[32:47]
    ds_read_b64_tr_b16 v[174:175], v204 offset:22272
    ds_read_b64_tr_b16 v[176:177], v204 offset:21568
    buffer_load_dwordx4 v211, s[8:11], s68 offen offset:1024 lds
    v_fma_f32 v238, v236, v236, -v232
    s_waitcnt lgkmcnt(8)
    v_mfma_f32_32x32x16_bf16 v[80:95], v[160:163], v[184:187], v[80:95]
    ds_read_b64_tr_b16 v[178:179], v204 offset:22336
    ds_read_b64_tr_b16 v[180:181], v204 offset:21632
    buffer_load_dwordx4 v212, s[8:11], s68 offen offset:2048 lds
    v_mul_f32 v232, v239, v239
    ds_read_b64_tr_b16 v[182:183], v204 offset:22400
    v_mfma_f32_32x32x16_bf16 v[96:111], v[164:167], v[184:187], v[96:111]
    v_mfma_f32_32x32x16_bf16 v[112:127], v[168:171], v[184:187], v[112:127]
    buffer_load_dwordx4 v213, s[8:11], s68 offen offset:3072 lds
    v_add_f32 v233, v238, v238
    s_waitcnt vmcnt(11) lgkmcnt(0)
    s_barrier
    v_mfma_f32_32x32x16_bf16 v[16:31], v[136:139], v[152:155], v[16:31]
    ds_read_b128 v[128:131], v192 offset:32768
    ds_read_b128 v[144:147], v196 offset:32768
    v_mfma_f32_32x32x16_bf16 v[48:63], v[140:143], v[152:155], v[48:63]
    ds_read_b128 v[132:135], v193 offset:36864
    v_mul_f32 v225, v233, v239
    ds_read_b128 v[148:151], v196 offset:40960
    v_mfma_f32_32x32x16_bf16 v[64:79], v[140:143], v[156:159], v[64:79]
    ds_read_b128 v[184:187], v200 offset:32768
    ds_read_b64_tr_b16 v[160:161], v204 offset:24576
    v_fma_f32 v224, v238, v238, -v232
    v_mfma_f32_32x32x16_bf16 v[32:47], v[136:139], v[156:159], v[32:47]
    ds_read_b64_tr_b16 v[162:163], v204 offset:25344
    ds_read_b64_tr_b16 v[164:165], v204 offset:24640
    s_add_u32 m0, s76, 12288
    s_add_u32 s68, s79, 7
    s_and_b32 s68, s68, 7
    s_mul_i32 s68, s68, 176128
    s_add_u32 s68, s68, s78
    v_mul_f32 v232, v225, v225
    v_mfma_f32_32x32x16_bf16 v[80:95], v[172:175], v[188:191], v[80:95]
    ds_read_b64_tr_b16 v[166:167], v204 offset:25408
    ds_read_b64_tr_b16 v[168:169], v204 offset:24704
    buffer_load_dwordx4 v214, s[52:55], s68 offen offset:0 lds
    v_add_f32 v233, v224, v224
    ds_read_b64_tr_b16 v[170:171], v204 offset:25472
    v_mfma_f32_32x32x16_bf16 v[96:111], v[176:179], v[188:191], v[96:111]
    v_mfma_f32_32x32x16_bf16 v[112:127], v[180:183], v[188:191], v[112:127]
    buffer_load_dwordx4 v215, s[52:55], s68 offen offset:1024 lds
    v_mul_f32 v227, v233, v225
    s_waitcnt lgkmcnt(7)
    v_mfma_f32_32x32x16_bf16 v[16:31], v[128:131], v[144:147], v[16:31]
    ds_read_b128 v[136:139], v193 offset:32768
    ds_read_b128 v[152:155], v197 offset:32768
    v_mfma_f32_32x32x16_bf16 v[48:63], v[132:135], v[144:147], v[48:63]
    ds_read_b128 v[140:143], v192 offset:36864
    v_fma_f32 v226, v224, v224, -v232
    ds_read_b128 v[156:159], v197 offset:40960
    v_mfma_f32_32x32x16_bf16 v[64:79], v[132:135], v[148:151], v[64:79]
    ds_read_b128 v[188:191], v201 offset:32768
    ds_read_b64_tr_b16 v[172:173], v204 offset:27648
    s_cmp_eq_u32 s88, 0
    s_cselect_b64 vcc, -1, 0
    v_mfma_f32_32x32x16_bf16 v[32:47], v[128:131], v[148:151], v[32:47]
    ds_read_b64_tr_b16 v[174:175], v204 offset:28416
    ds_read_b64_tr_b16 v[176:177], v204 offset:27712
    buffer_load_dwordx4 v216, s[52:55], s68 offen offset:2048 lds
    s_add_u32 m0, s75, 16384
    s_add_u32 s68, s79, 7
    s_and_b32 s68, s68, 7
    s_mul_i32 s68, s68, 128
    s_add_u32 s68, s68, s73
    v_cndmask_b32 v238, v238, 1.0, vcc
    s_waitcnt lgkmcnt(8)
    v_mfma_f32_32x32x16_bf16 v[80:95], v[160:163], v[184:187], v[80:95]
    ds_read_b64_tr_b16 v[178:179], v204 offset:28480
    ds_read_b64_tr_b16 v[180:181], v204 offset:27776
    buffer_load_dwordx4 v206, s[4:7], s68 offen offset:0 lds
    v_cndmask_b32 v239, v239, 0, vcc
    ds_read_b64_tr_b16 v[182:183], v204 offset:28544
    v_mfma_f32_32x32x16_bf16 v[96:111], v[164:167], v[184:187], v[96:111]
    v_mfma_f32_32x32x16_bf16 v[112:127], v[168:171], v[184:187], v[112:127]
    buffer_load_dwordx4 v207, s[4:7], s68 offen offset:1024 lds
    v_cmp_gt_u32 vcc, 32, v1
    s_waitcnt lgkmcnt(7)
    v_mfma_f32_32x32x16_bf16 v[16:31], v[136:139], v[152:155], v[16:31]
    ds_read_b128 v[128:131], v194 offset:32768
    ds_read_b128 v[144:147], v198 offset:32768
    v_mfma_f32_32x32x16_bf16 v[48:63], v[140:143], v[152:155], v[48:63]
    ds_read_b128 v[132:135], v195 offset:36864
    v_cndmask_b32 v228, v236, 1.0, vcc
    ds_read_b128 v[148:151], v198 offset:40960
    v_mfma_f32_32x32x16_bf16 v[64:79], v[140:143], v[156:159], v[64:79]
    ds_read_b128 v[184:187], v202 offset:32768
    ds_read_b64_tr_b16 v[160:161], v204 offset:30720
    v_cndmask_b32 v229, v237, 0, vcc
    v_mfma_f32_32x32x16_bf16 v[32:47], v[136:139], v[156:159], v[32:47]
    ds_read_b64_tr_b16 v[162:163], v204 offset:31488
    ds_read_b64_tr_b16 v[164:165], v204 offset:30784
    buffer_load_dwordx4 v208, s[4:7], s68 offen offset:2048 lds
    v_mul_f32 v232, v229, v239
    s_waitcnt lgkmcnt(8)
    v_mfma_f32_32x32x16_bf16 v[80:95], v[172:175], v[188:191], v[80:95]
    ds_read_b64_tr_b16 v[166:167], v204 offset:31552
    ds_read_b64_tr_b16 v[168:169], v204 offset:30848
    buffer_load_dwordx4 v209, s[4:7], s68 offen offset:3072 lds
    s_add_u32 m0, s75, 65536
    s_add_u32 s68, s79, 7
    s_and_b32 s68, s68, 7
    s_mul_i32 s68, s68, 128
    s_add_u32 s68, s68, s74
    v_mul_f32 v233, v229, v238
    ds_read_b64_tr_b16 v[170:171], v204 offset:31616
    v_mfma_f32_32x32x16_bf16 v[96:111], v[176:179], v[188:191], v[96:111]
    v_mfma_f32_32x32x16_bf16 v[112:127], v[180:183], v[188:191], v[112:127]
    buffer_load_dwordx4 v210, s[8:11], s68 offen offset:0 lds
    v_fma_f32 v232, v228, v238, -v232
    s_waitcnt lgkmcnt(7)
    v_mfma_f32_32x32x16_bf16 v[16:31], v[128:131], v[144:147], v[16:31]
    ds_read_b128 v[136:139], v195 offset:32768
    ds_read_b128 v[152:155], v199 offset:32768
    v_mfma_f32_32x32x16_bf16 v[48:63], v[132:135], v[144:147], v[48:63]
    ds_read_b128 v[140:143], v194 offset:36864
    v_fma_f32 v229, v228, v239, v233
    ds_read_b128 v[156:159], v199 offset:40960
    v_mfma_f32_32x32x16_bf16 v[64:79], v[132:135], v[148:151], v[64:79]
    ds_read_b128 v[188:191], v203 offset:32768
    ds_read_b64_tr_b16 v[172:173], v204 offset:33792
    v_mov_b32 v228, v232
    v_mfma_f32_32x32x16_bf16 v[32:47], v[128:131], v[148:151], v[32:47]
    ds_read_b64_tr_b16 v[174:175], v204 offset:34560
    ds_read_b64_tr_b16 v[176:177], v204 offset:33856
    buffer_load_dwordx4 v211, s[8:11], s68 offen offset:1024 lds
    v_mul_f32 v232, v229, v223
    s_waitcnt lgkmcnt(8)
    v_mfma_f32_32x32x16_bf16 v[80:95], v[160:163], v[184:187], v[80:95]
    ds_read_b64_tr_b16 v[178:179], v204 offset:34624
    ds_read_b64_tr_b16 v[180:181], v204 offset:33920
    buffer_load_dwordx4 v212, s[8:11], s68 offen offset:2048 lds
    v_mul_f32 v233, v229, v222
    ds_read_b64_tr_b16 v[182:183], v204 offset:34688
    v_mfma_f32_32x32x16_bf16 v[96:111], v[164:167], v[184:187], v[96:111]
    v_mfma_f32_32x32x16_bf16 v[112:127], v[168:171], v[184:187], v[112:127]
    buffer_load_dwordx4 v213, s[8:11], s68 offen offset:3072 lds
    v_fma_f32 v232, v228, v222, -v232
    s_waitcnt vmcnt(11) lgkmcnt(0)
    s_barrier
    v_mfma_f32_32x32x16_bf16 v[16:31], v[136:139], v[152:155], v[16:31]
    ds_read_b128 v[128:131], v192 offset:0
    ds_read_b128 v[144:147], v196 offset:0
    v_mfma_f32_32x32x16_bf16 v[48:63], v[140:143], v[152:155], v[48:63]
    ds_read_b128 v[132:135], v193 offset:4096
    ds_read_b128 v[148:151], v196 offset:8192
    v_mfma_f32_32x32x16_bf16 v[64:79], v[140:143], v[156:159], v[64:79]
    ds_read_b128 v[184:187], v200 offset:0
    ds_read_b64_tr_b16 v[160:161], v204 offset:0
    v_mfma_f32_32x32x16_bf16 v[32:47], v[136:139], v[156:159], v[32:47]
    ds_read_b64_tr_b16 v[162:163], v204 offset:768
    v_fma_f32 v231, v228, v223, v233
    ds_read_b64_tr_b16 v[164:165], v204 offset:64
    s_add_u32 m0, s90, 0
    s_add_u32 s68, s69, 0
    v_mfma_f32_32x32x16_bf16 v[80:95], v[172:175], v[188:191], v[80:95]
    ds_read_b64_tr_b16 v[166:167], v204 offset:832
    ds_read_b64_tr_b16 v[168:169], v204 offset:128
    buffer_load_dwordx4 v240, s[12:15], s68 offen offset:0  lds
    ds_read_b64_tr_b16 v[170:171], v204 offset:896
    v_mfma_f32_32x32x16_bf16 v[96:111], v[176:179], v[188:191], v[96:111]
    v_mfma_f32_32x32x16_bf16 v[112:127], v[180:183], v[188:191], v[112:127]
    buffer_load_dwordx4 v241, s[12:15], s68 offen offset:1024  lds
    v_mov_b32 v230, v232
    s_waitcnt lgkmcnt(7)
    v_mfma_f32_32x32x16_bf16 v[16:31], v[128:131], v[144:147], v[16:31]
    ds_read_b128 v[136:139], v193 offset:0
    ds_read_b128 v[152:155], v197 offset:0
    v_mfma_f32_32x32x16_bf16 v[48:63], v[132:135], v[144:147], v[48:63]
    ds_read_b128 v[140:143], v192 offset:4096
    ds_read_b128 v[156:159], v197 offset:8192
    v_mfma_f32_32x32x16_bf16 v[64:79], v[132:135], v[148:151], v[64:79]
    ds_read_b128 v[188:191], v201 offset:0
    ds_read_b64_tr_b16 v[172:173], v204 offset:3072
    v_mfma_f32_32x32x16_bf16 v[32:47], v[128:131], v[148:151], v[32:47]
    ds_read_b64_tr_b16 v[174:175], v204 offset:3840
    ds_read_b64_tr_b16 v[176:177], v204 offset:3136
    buffer_load_dwordx4 v242, s[12:15], s68 offen offset:2048  lds
    s_waitcnt lgkmcnt(8)
    v_mfma_f32_32x32x16_bf16 v[80:95], v[160:163], v[184:187], v[80:95]
    ds_read_b64_tr_b16 v[178:179], v204 offset:3904
    ds_read_b64_tr_b16 v[180:181], v204 offset:3200
    buffer_load_dwordx4 v243, s[12:15], s68 offen offset:3072  lds
    s_add_u32 m0, s90, 4096
    s_add_u32 s68, s69, 131072
    ds_read_b64_tr_b16 v[182:183], v204 offset:3968
    v_mfma_f32_32x32x16_bf16 v[96:111], v[164:167], v[184:187], v[96:111]
    v_mfma_f32_32x32x16_bf16 v[112:127], v[168:171], v[184:187], v[112:127]
    buffer_load_dwordx4 v240, s[12:15], s68 offen offset:0  lds
    s_waitcnt lgkmcnt(7)
    v_mfma_f32_32x32x16_bf16 v[16:31], v[136:139], v[152:155], v[16:31]
    ds_read_b128 v[128:131], v194 offset:0
    ds_read_b128 v[144:147], v198 offset:0
    v_mfma_f32_32x32x16_bf16 v[48:63], v[140:143], v[152:155], v[48:63]
    ds_read_b128 v[132:135], v195 offset:4096
    ds_read_b128 v[148:151], v198 offset:8192
    v_mfma_f32_32x32x16_bf16 v[64:79], v[140:143], v[156:159], v[64:79]
    ds_read_b128 v[184:187], v202 offset:0
    ds_read_b64_tr_b16 v[160:161], v204 offset:6144
    v_mfma_f32_32x32x16_bf16 v[32:47], v[136:139], v[156:159], v[32:47]
    ds_read_b64_tr_b16 v[162:163], v204 offset:6912
    ds_read_b64_tr_b16 v[164:165], v204 offset:6208
    buffer_load_dwordx4 v241, s[12:15], s68 offen offset:1024  lds
    s_waitcnt lgkmcnt(8)
    v_mfma_f32_32x32x16_bf16 v[80:95], v[172:175], v[188:191], v[80:95]
    ds_read_b64_tr_b16 v[166:167], v204 offset:6976
    ds_read_b64_tr_b16 v[168:169], v204 offset:6272
    buffer_load_dwordx4 v242, s[12:15], s68 offen offset:2048  lds
    ds_read_b64_tr_b16 v[170:171], v204 offset:7040
    v_mfma_f32_32x32x16_bf16 v[96:111], v[176:179], v[188:191], v[96:111]
    v_mfma_f32_32x32x16_bf16 v[112:127], v[180:183], v[188:191], v[112:127]
    buffer_load_dwordx4 v243, s[12:15], s68 offen offset:3072  lds
    s_waitcnt lgkmcnt(7)
    v_mfma_f32_32x32x16_bf16 v[16:31], v[128:131], v[144:147], v[16:31]
    ds_read_b128 v[136:139], v195 offset:0
    ds_read_b128 v[152:155], v199 offset:0
    v_mfma_f32_32x32x16_bf16 v[48:63], v[132:135], v[144:147], v[48:63]
    ds_read_b128 v[140:143], v194 offset:4096
    ds_read_b128 v[156:159], v199 offset:8192
    v_mfma_f32_32x32x16_bf16 v[64:79], v[132:135], v[148:151], v[64:79]
    ds_read_b128 v[188:191], v203 offset:0
    ds_read_b64_tr_b16 v[172:173], v204 offset:9216
    v_mfma_f32_32x32x16_bf16 v[32:47], v[128:131], v[148:151], v[32:47]
    ds_read_b64_tr_b16 v[174:175], v204 offset:9984
    ds_read_b64_tr_b16 v[176:177], v204 offset:9280
    s_waitcnt lgkmcnt(8)
    v_mfma_f32_32x32x16_bf16 v[80:95], v[160:163], v[184:187], v[80:95]
    ds_read_b64_tr_b16 v[178:179], v204 offset:10048
    ds_read_b64_tr_b16 v[180:181], v204 offset:9344
    ds_read_b64_tr_b16 v[182:183], v204 offset:10112
    v_mfma_f32_32x32x16_bf16 v[96:111], v[164:167], v[184:187], v[96:111]
    v_mfma_f32_32x32x16_bf16 v[112:127], v[168:171], v[184:187], v[112:127]
    s_waitcnt vmcnt(8) lgkmcnt(0)
    s_barrier
    v_mfma_f32_32x32x16_bf16 v[16:31], v[136:139], v[152:155], v[16:31]
    ds_read_b128 v[128:131], v192 offset:16384
    ds_read_b128 v[144:147], v196 offset:16384
    v_mfma_f32_32x32x16_bf16 v[48:63], v[140:143], v[152:155], v[48:63]
    ds_read_b128 v[132:135], v193 offset:20480
    ds_read_b128 v[148:151], v196 offset:24576
    v_mfma_f32_32x32x16_bf16 v[64:79], v[140:143], v[156:159], v[64:79]
    ds_read_b128 v[184:187], v200 offset:16384
    ds_read_b64_tr_b16 v[160:161], v204 offset:12288
    v_mfma_f32_32x32x16_bf16 v[32:47], v[136:139], v[156:159], v[32:47]
    ds_read_b64_tr_b16 v[162:163], v204 offset:13056
    ds_read_b64_tr_b16 v[164:165], v204 offset:12352
    s_add_u32 m0, s91, 0
    s_add_u32 s68, s69, 128
    v_mfma_f32_32x32x16_bf16 v[80:95], v[172:175], v[188:191], v[80:95]
    ds_read_b64_tr_b16 v[166:167], v204 offset:13120
    ds_read_b64_tr_b16 v[168:169], v204 offset:12416
    buffer_load_dwordx4 v240, s[12:15], s68 offen offset:0  lds
    ds_read_b64_tr_b16 v[170:171], v204 offset:13184
    v_mfma_f32_32x32x16_bf16 v[96:111], v[176:179], v[188:191], v[96:111]
    v_mfma_f32_32x32x16_bf16 v[112:127], v[180:183], v[188:191], v[112:127]
    buffer_load_dwordx4 v241, s[12:15], s68 offen offset:1024  lds
    s_waitcnt lgkmcnt(7)
    v_mfma_f32_32x32x16_bf16 v[16:31], v[128:131], v[144:147], v[16:31]
    ds_read_b128 v[136:139], v193 offset:16384
    ds_read_b128 v[152:155], v197 offset:16384
    v_mfma_f32_32x32x16_bf16 v[48:63], v[132:135], v[144:147], v[48:63]
    ds_read_b128 v[140:143], v192 offset:20480
    ds_read_b128 v[156:159], v197 offset:24576
    v_mfma_f32_32x32x16_bf16 v[64:79], v[132:135], v[148:151], v[64:79]
    ds_read_b128 v[188:191], v201 offset:16384
    ds_read_b64_tr_b16 v[172:173], v204 offset:15360
    v_mfma_f32_32x32x16_bf16 v[32:47], v[128:131], v[148:151], v[32:47]
    ds_read_b64_tr_b16 v[174:175], v204 offset:16128
    ds_read_b64_tr_b16 v[176:177], v204 offset:15424
    buffer_load_dwordx4 v242, s[12:15], s68 offen offset:2048  lds
    s_waitcnt lgkmcnt(8)
    v_mfma_f32_32x32x16_bf16 v[80:95], v[160:163], v[184:187], v[80:95]
    ds_read_b64_tr_b16 v[178:179], v204 offset:16192
    ds_read_b64_tr_b16 v[180:181], v204 offset:15488
    buffer_load_dwordx4 v243, s[12:15], s68 offen offset:3072  lds
    s_add_u32 m0, s91, 4096
    s_add_u32 s68, s69, 131200
    ds_read_b64_tr_b16 v[182:183], v204 offset:16256
    v_mfma_f32_32x32x16_bf16 v[96:111], v[164:167], v[184:187], v[96:111]
    v_mfma_f32_32x32x16_bf16 v[112:127], v[168:171], v[184:187], v[112:127]
    buffer_load_dwordx4 v240, s[12:15], s68 offen offset:0  lds
    s_waitcnt lgkmcnt(7)
    v_mfma_f32_32x32x16_bf16 v[16:31], v[136:139], v[152:155], v[16:31]
    ds_read_b128 v[128:131], v194 offset:16384
    ds_read_b128 v[144:147], v198 offset:16384
    v_mfma_f32_32x32x16_bf16 v[48:63], v[140:143], v[152:155], v[48:63]
    ds_read_b128 v[132:135], v195 offset:20480
    ds_read_b128 v[148:151], v198 offset:24576
    v_mfma_f32_32x32x16_bf16 v[64:79], v[140:143], v[156:159], v[64:79]
    ds_read_b128 v[184:187], v202 offset:16384
    ds_read_b64_tr_b16 v[160:161], v204 offset:18432
    v_mfma_f32_32x32x16_bf16 v[32:47], v[136:139], v[156:159], v[32:47]
    ds_read_b64_tr_b16 v[162:163], v204 offset:19200
    ds_read_b64_tr_b16 v[164:165], v204 offset:18496
    buffer_load_dwordx4 v241, s[12:15], s68 offen offset:1024  lds
    s_waitcnt lgkmcnt(8)
    v_mfma_f32_32x32x16_bf16 v[80:95], v[172:175], v[188:191], v[80:95]
    ds_read_b64_tr_b16 v[166:167], v204 offset:19264
    ds_read_b64_tr_b16 v[168:169], v204 offset:18560
    buffer_load_dwordx4 v242, s[12:15], s68 offen offset:2048  lds
    ds_read_b64_tr_b16 v[170:171], v204 offset:19328
    v_mfma_f32_32x32x16_bf16 v[96:111], v[176:179], v[188:191], v[96:111]
    v_mfma_f32_32x32x16_bf16 v[112:127], v[180:183], v[188:191], v[112:127]
    buffer_load_dwordx4 v243, s[12:15], s68 offen offset:3072  lds
    s_waitcnt lgkmcnt(7)
    v_mfma_f32_32x32x16_bf16 v[16:31], v[128:131], v[144:147], v[16:31]
    ds_read_b128 v[136:139], v195 offset:16384
    ds_read_b128 v[152:155], v199 offset:16384
    v_mfma_f32_32x32x16_bf16 v[48:63], v[132:135], v[144:147], v[48:63]
    ds_read_b128 v[140:143], v194 offset:20480
    ds_read_b128 v[156:159], v199 offset:24576
    v_mfma_f32_32x32x16_bf16 v[64:79], v[132:135], v[148:151], v[64:79]
    ds_read_b128 v[188:191], v203 offset:16384
    ds_read_b64_tr_b16 v[172:173], v204 offset:21504
    v_mfma_f32_32x32x16_bf16 v[32:47], v[128:131], v[148:151], v[32:47]
    ds_read_b64_tr_b16 v[174:175], v204 offset:22272
    ds_read_b64_tr_b16 v[176:177], v204 offset:21568
    s_waitcnt lgkmcnt(8)
    v_mfma_f32_32x32x16_bf16 v[80:95], v[160:163], v[184:187], v[80:95]
    ds_read_b64_tr_b16 v[178:179], v204 offset:22336
    ds_read_b64_tr_b16 v[180:181], v204 offset:21632
    ds_read_b64_tr_b16 v[182:183], v204 offset:22400
    v_mfma_f32_32x32x16_bf16 v[96:111], v[164:167], v[184:187], v[96:111]
    v_mfma_f32_32x32x16_bf16 v[112:127], v[168:171], v[184:187], v[112:127]
    s_waitcnt lgkmcnt(7)
    v_mfma_f32_32x32x16_bf16 v[16:31], v[136:139], v[152:155], v[16:31]
    v_mfma_f32_32x32x16_bf16 v[48:63], v[140:143], v[152:155], v[48:63]
    v_mfma_f32_32x32x16_bf16 v[64:79], v[140:143], v[156:159], v[64:79]
    v_mfma_f32_32x32x16_bf16 v[32:47], v[136:139], v[156:159], v[32:47]
    s_waitcnt lgkmcnt(0)
    v_mfma_f32_32x32x16_bf16 v[80:95], v[172:175], v[188:191], v[80:95]
    v_mfma_f32_32x32x16_bf16 v[96:111], v[176:179], v[188:191], v[96:111]
    v_mfma_f32_32x32x16_bf16 v[112:127], v[180:183], v[188:191], v[112:127]
    s_lshl_b32 s60, s89, 11
    s_add_u32 s60, s60, 98304
    v_and_b32 v160, 31, v1
    v_lshlrev_b32 v160, 6, v160
    v_add_u32 v160, s60, v160
    v_lshrrev_b32 v161, 5, v1
    v_lshl_add_u32 v161, v161, 4, v160
    s_lshl_b32 s60, s88, 5
    v_add_u32 v161, s60, v161
    s_lshl_b32 s60, s57, 2
    s_add_u32 s60, s60, s56
    s_mul_i32 s60, s60, 45056
    s_mul_i32 s61, s58, 6144
    s_add_u32 s60, s60, s61
    s_add_u32 s75, s60, 4194304
    s_add_u32 s76, s75, 4096
    s_cmp_lt_u32 s58, 7
    s_cselect_b64 vcc, -1, 0
    v_cndmask_b32 v176, v3, v2, vcc
    v_cvt_pk_bf16_f32 v192, v80, v81
    v_cvt_pk_bf16_f32 v193, v82, v83
    v_cvt_pk_bf16_f32 v194, v84, v85
    v_cvt_pk_bf16_f32 v195, v86, v87
    buffer_store_dwordx4 v[192:195], v2, s[16:19], s75 offen offset:0 sc1
    v_cvt_pk_bf16_f32 v196, v88, v89
    v_cvt_pk_bf16_f32 v197, v90, v91
    v_cvt_pk_bf16_f32 v198, v92, v93
    v_cvt_pk_bf16_f32 v199, v94, v95
    buffer_store_dwordx4 v[196:199], v176, s[16:19], s75 offen offset:1024 sc1
    s_barrier
    v_pk_fma_f32 v[136:137], v[218:219], v[16:17], v[18:19] op_sel_hi:[0,1,1]
    v_pk_fma_f32 v[138:139], v[218:219], v[32:33], v[34:35] op_sel_hi:[0,1,1]
    v_pk_fma_f32 v[128:129], v[218:219], v[32:33], v[136:137] op_sel:[1,0,0] op_sel_hi:[1,1,1] neg_lo:[1,0,0] neg_hi:[1,0,0]
    v_pk_fma_f32 v[130:131], v[218:219], v[16:17], v[138:139] op_sel:[1,0,0] op_sel_hi:[1,1,1]
    v_pk_fma_f32 v[136:137], v[218:219], v[128:129], v[20:21] op_sel_hi:[0,1,1]
    v_pk_fma_f32 v[138:139], v[218:219], v[130:131], v[36:37] op_sel_hi:[0,1,1]
    v_pk_fma_f32 v[132:133], v[218:219], v[130:131], v[136:137] op_sel:[1,0,0] op_sel_hi:[1,1,1] neg_lo:[1,0,0] neg_hi:[1,0,0]
    v_pk_fma_f32 v[134:135], v[218:219], v[128:129], v[138:139] op_sel:[1,0,0] op_sel_hi:[1,1,1]
    v_pk_fma_f32 v[136:137], v[218:219], v[132:133], v[22:23] op_sel_hi:[0,1,1]
    v_pk_fma_f32 v[138:139], v[218:219], v[134:135], v[38:39] op_sel_hi:[0,1,1]
    s_add_u32 m0, s92, 0
    s_add_u32 s68, s69, 256
    v_pk_fma_f32 v[128:129], v[218:219], v[134:135], v[136:137] op_sel:[1,0,0] op_sel_hi:[1,1,1] neg_lo:[1,0,0] neg_hi:[1,0,0]
    v_pk_fma_f32 v[130:131], v[218:219], v[132:133], v[138:139] op_sel:[1,0,0] op_sel_hi:[1,1,1]
    v_pk_fma_f32 v[136:137], v[218:219], v[128:129], v[24:25] op_sel_hi:[0,1,1]
    v_pk_fma_f32 v[138:139], v[218:219], v[130:131], v[40:41] op_sel_hi:[0,1,1]
    v_pk_fma_f32 v[132:133], v[218:219], v[130:131], v[136:137] op_sel:[1,0,0] op_sel_hi:[1,1,1] neg_lo:[1,0,0] neg_hi:[1,0,0]
    v_pk_fma_f32 v[134:135], v[218:219], v[128:129], v[138:139] op_sel:[1,0,0] op_sel_hi:[1,1,1]
    v_cvt_pk_bf16_f32 v200, v96, v97
    v_cvt_pk_bf16_f32 v201, v98, v99
    v_cvt_pk_bf16_f32 v202, v100, v101
    v_cvt_pk_bf16_f32 v203, v102, v103
    buffer_store_dwordx4 v[200:203], v176, s[16:19], s75 offen offset:2048 sc1
    v_pk_fma_f32 v[136:137], v[218:219], v[132:133], v[26:27] op_sel_hi:[0,1,1]
    v_pk_fma_f32 v[138:139], v[218:219], v[134:135], v[42:43] op_sel_hi:[0,1,1]
    v_pk_fma_f32 v[128:129], v[218:219], v[134:135], v[136:137] op_sel:[1,0,0] op_sel_hi:[1,1,1] neg_lo:[1,0,0] neg_hi:[1,0,0]
    buffer_load_dwordx4 v240, s[12:15], s68 offen offset:0  lds
    v_pk_fma_f32 v[130:131], v[218:219], v[132:133], v[138:139] op_sel:[1,0,0] op_sel_hi:[1,1,1]
    v_pk_fma_f32 v[136:137], v[218:219], v[128:129], v[28:29] op_sel_hi:[0,1,1]
    v_pk_fma_f32 v[138:139], v[218:219], v[130:131], v[44:45] op_sel_hi:[0,1,1]
    v_pk_fma_f32 v[132:133], v[218:219], v[130:131], v[136:137] op_sel:[1,0,0] op_sel_hi:[1,1,1] neg_lo:[1,0,0] neg_hi:[1,0,0]
    v_pk_fma_f32 v[134:135], v[218:219], v[128:129], v[138:139] op_sel:[1,0,0] op_sel_hi:[1,1,1]
    v_pk_fma_f32 v[136:137], v[218:219], v[132:133], v[30:31] op_sel_hi:[0,1,1]
    v_pk_fma_f32 v[138:139], v[218:219], v[134:135], v[46:47] op_sel_hi:[0,1,1]
    v_pk_fma_f32 v[128:129], v[218:219], v[134:135], v[136:137] op_sel:[1,0,0] op_sel_hi:[1,1,1] neg_lo:[1,0,0] neg_hi:[1,0,0]
    v_pk_fma_f32 v[130:131], v[218:219], v[132:133], v[138:139] op_sel:[1,0,0] op_sel_hi:[1,1,1]
    v_pk_fma_f32 v[136:137], v[218:219], v[128:129], v[48:49] op_sel_hi:[0,1,1]
    buffer_load_dwordx4 v241, s[12:15], s68 offen offset:1024  lds
    v_pk_fma_f32 v[138:139], v[218:219], v[130:131], v[64:65] op_sel_hi:[0,1,1]
    v_pk_fma_f32 v[132:133], v[218:219], v[130:131], v[136:137] op_sel:[1,0,0] op_sel_hi:[1,1,1] neg_lo:[1,0,0] neg_hi:[1,0,0]
    v_pk_fma_f32 v[134:135], v[218:219], v[128:129], v[138:139] op_sel:[1,0,0] op_sel_hi:[1,1,1]
    v_cvt_pk_bf16_f32 v204, v104, v105
    v_cvt_pk_bf16_f32 v205, v106, v107
    v_cvt_pk_bf16_f32 v206, v108, v109
    v_cvt_pk_bf16_f32 v207, v110, v111
    buffer_store_dwordx4 v[204:207], v176, s[16:19], s75 offen offset:3072 sc1
    v_pk_fma_f32 v[136:137], v[218:219], v[132:133], v[50:51] op_sel_hi:[0,1,1]
    v_pk_fma_f32 v[138:139], v[218:219], v[134:135], v[66:67] op_sel_hi:[0,1,1]
    v_pk_fma_f32 v[128:129], v[218:219], v[134:135], v[136:137] op_sel:[1,0,0] op_sel_hi:[1,1,1] neg_lo:[1,0,0] neg_hi:[1,0,0]
    v_pk_fma_f32 v[130:131], v[218:219], v[132:133], v[138:139] op_sel:[1,0,0] op_sel_hi:[1,1,1]
    v_pk_fma_f32 v[136:137], v[218:219], v[128:129], v[52:53] op_sel_hi:[0,1,1]
    buffer_load_dwordx4 v242, s[12:15], s68 offen offset:2048  lds
    v_pk_fma_f32 v[138:139], v[218:219], v[130:131], v[68:69] op_sel_hi:[0,1,1]
    v_pk_fma_f32 v[132:133], v[218:219], v[130:131], v[136:137] op_sel:[1,0,0] op_sel_hi:[1,1,1] neg_lo:[1,0,0] neg_hi:[1,0,0]
    v_pk_fma_f32 v[134:135], v[218:219], v[128:129], v[138:139] op_sel:[1,0,0] op_sel_hi:[1,1,1]
    v_pk_fma_f32 v[136:137], v[218:219], v[132:133], v[54:55] op_sel_hi:[0,1,1]
    v_pk_fma_f32 v[138:139], v[218:219], v[134:135], v[70:71] op_sel_hi:[0,1,1]
    v_pk_fma_f32 v[128:129], v[218:219], v[134:135], v[136:137] op_sel:[1,0,0] op_sel_hi:[1,1,1] neg_lo:[1,0,0] neg_hi:[1,0,0]
    v_pk_fma_f32 v[130:131], v[218:219], v[132:133], v[138:139] op_sel:[1,0,0] op_sel_hi:[1,1,1]
    v_pk_fma_f32 v[136:137], v[218:219], v[128:129], v[56:57] op_sel_hi:[0,1,1]
    v_pk_fma_f32 v[138:139], v[218:219], v[130:131], v[72:73] op_sel_hi:[0,1,1]
    v_pk_fma_f32 v[132:133], v[218:219], v[130:131], v[136:137] op_sel:[1,0,0] op_sel_hi:[1,1,1] neg_lo:[1,0,0] neg_hi:[1,0,0]
    buffer_load_dwordx4 v243, s[12:15], s68 offen offset:3072  lds
    s_add_u32 m0, s92, 4096
    s_add_u32 s68, s69, 131328
    v_pk_fma_f32 v[134:135], v[218:219], v[128:129], v[138:139] op_sel:[1,0,0] op_sel_hi:[1,1,1]
    v_cvt_pk_bf16_f32 v208, v112, v113
    v_cvt_pk_bf16_f32 v209, v114, v115
    v_cvt_pk_bf16_f32 v210, v116, v117
    v_cvt_pk_bf16_f32 v211, v118, v119
    buffer_store_dwordx4 v[208:211], v176, s[16:19], s76 offen offset:0 sc1
    v_pk_fma_f32 v[136:137], v[218:219], v[132:133], v[58:59] op_sel_hi:[0,1,1]
    v_pk_fma_f32 v[138:139], v[218:219], v[134:135], v[74:75] op_sel_hi:[0,1,1]
    v_pk_fma_f32 v[128:129], v[218:219], v[134:135], v[136:137] op_sel:[1,0,0] op_sel_hi:[1,1,1] neg_lo:[1,0,0] neg_hi:[1,0,0]
    v_pk_fma_f32 v[130:131], v[218:219], v[132:133], v[138:139] op_sel:[1,0,0] op_sel_hi:[1,1,1]
    v_pk_fma_f32 v[136:137], v[218:219], v[128:129], v[60:61] op_sel_hi:[0,1,1]
    v_pk_fma_f32 v[138:139], v[218:219], v[130:131], v[76:77] op_sel_hi:[0,1,1]
    v_pk_fma_f32 v[132:133], v[218:219], v[130:131], v[136:137] op_sel:[1,0,0] op_sel_hi:[1,1,1] neg_lo:[1,0,0] neg_hi:[1,0,0]
    v_pk_fma_f32 v[134:135], v[218:219], v[128:129], v[138:139] op_sel:[1,0,0] op_sel_hi:[1,1,1]
    buffer_load_dwordx4 v240, s[12:15], s68 offen offset:0  lds
    v_pk_fma_f32 v[136:137], v[218:219], v[132:133], v[62:63] op_sel_hi:[0,1,1]
    v_pk_fma_f32 v[138:139], v[218:219], v[134:135], v[78:79] op_sel_hi:[0,1,1]
    v_pk_fma_f32 v[128:129], v[218:219], v[134:135], v[136:137] op_sel:[1,0,0] op_sel_hi:[1,1,1] neg_lo:[1,0,0] neg_hi:[1,0,0]
    v_pk_fma_f32 v[130:131], v[218:219], v[132:133], v[138:139] op_sel:[1,0,0] op_sel_hi:[1,1,1]
    v_mov_b32 v140, v128
    v_mov_b32 v141, v130
    v_mov_b32 v142, v129
    v_mov_b32 v143, v131
    v_cvt_pk_bf16_f32 v212, v120, v121
    v_cvt_pk_bf16_f32 v213, v122, v123
    v_cvt_pk_bf16_f32 v214, v124, v125
    v_cvt_pk_bf16_f32 v215, v126, v127
    buffer_store_dwordx4 v[212:215], v176, s[16:19], s76 offen offset:1024 sc1
    buffer_load_dwordx4 v241, s[12:15], s68 offen offset:1024  lds
    ds_write_b128 v161, v[140:143]
    s_waitcnt lgkmcnt(0)
    s_barrier
    ds_read_b128 v[144:147], v160 offset:0
    ds_read_b128 v[148:151], v160 offset:16
    ds_read_b128 v[152:155], v160 offset:32
    ds_read_b128 v[156:159], v160 offset:48
    buffer_load_dwordx4 v242, s[12:15], s68 offen offset:2048  lds
    buffer_load_dwordx4 v243, s[12:15], s68 offen offset:3072  lds
    s_add_u32 m0, s93, 0
    s_add_u32 s68, s69, 384
    buffer_load_dwordx4 v240, s[12:15], s68 offen offset:0  lds
    s_cmp_eq_u32 s88, 0
    s_cselect_b32 s60, 32, 0
    v_cmp_gt_u32 vcc, s60, v1
    v_mov_b32 v165, s100
    v_mov_b32 v167, s100
    v_cndmask_b32 v136, v3, v2, vcc
    s_lshl_b32 s62, s58, 14
    s_lshl_b32 s60, s89, 9
    s_add_u32 s62, s62, s60
    s_add_u32 s62, s62, 327680
    s_lshl_b32 s60, s57, 10
    s_add_u32 s60, s60, s62
    s_waitcnt lgkmcnt(0)
    s_barrier
    v_fma_f32 v232, v222, v144, v146
    v_fma_f32 v233, v222, v145, v147
    v_fma_f32 v232, -v223, v145, v232
    v_fma_f32 v147, v223, v144, v233
    v_mov_b32 v146, v232
    v_fma_f32 v232, v222, v146, v148
    v_fma_f32 v233, v222, v147, v149
    v_fma_f32 v232, -v223, v147, v232
    v_fma_f32 v149, v223, v146, v233
    buffer_load_dwordx4 v241, s[12:15], s68 offen offset:1024  lds
    v_mov_b32 v148, v232
    v_fma_f32 v232, v222, v148, v150
    v_fma_f32 v233, v222, v149, v151
    v_fma_f32 v232, -v223, v149, v232
    v_fma_f32 v151, v223, v148, v233
    v_mov_b32 v150, v232
    v_fma_f32 v232, v222, v150, v152
    v_fma_f32 v233, v222, v151, v153
    v_fma_f32 v232, -v223, v151, v232
    buffer_load_dwordx4 v242, s[12:15], s68 offen offset:2048  lds
    v_fma_f32 v153, v223, v150, v233
    v_mov_b32 v152, v232
    v_fma_f32 v232, v222, v152, v154
    v_fma_f32 v233, v222, v153, v155
    v_fma_f32 v232, -v223, v153, v232
    v_fma_f32 v155, v223, v152, v233
    v_mov_b32 v154, v232
    v_fma_f32 v232, v222, v154, v156
    v_fma_f32 v233, v222, v155, v157
    buffer_load_dwordx4 v243, s[12:15], s68 offen offset:3072  lds
    s_add_u32 m0, s93, 4096
    s_add_u32 s68, s69, 131456
    v_fma_f32 v232, -v223, v155, v232
    v_fma_f32 v157, v223, v154, v233
    v_mov_b32 v156, v232
    v_fma_f32 v232, v222, v156, v158
    v_fma_f32 v233, v222, v157, v159
    v_fma_f32 v232, -v223, v157, v232
    v_fma_f32 v159, v223, v156, v233
    v_mov_b32 v158, v232
    buffer_load_dwordx4 v240, s[12:15], s68 offen offset:0  lds
    v_mov_b32 v164, v158
    v_mov_b32 v166, v159
    buffer_store_dwordx4 v[164:167], v136, s[16:19], s60 offen sc1
    buffer_load_dwordx4 v241, s[12:15], s68 offen offset:1024  lds
    buffer_load_dwordx4 v242, s[12:15], s68 offen offset:2048  lds
    buffer_load_dwordx4 v243, s[12:15], s68 offen offset:3072  lds
    v_cmp_gt_u32 vcc, 32, v1
    s_cmp_eq_u32 s88, 0
    s_cbranch_scc0 .Lw1_7
    v_cndmask_b32 v168, v146, 0, vcc
    v_cndmask_b32 v169, v147, 0, vcc
    v_cndmask_b32 v170, v148, v144, vcc
    v_cndmask_b32 v171, v149, v145, vcc
    s_branch .Lw2_8
.Lw1_7:
    v_cndmask_b32 v168, v154, v150, vcc
    v_cndmask_b32 v169, v155, v151, vcc
    v_cndmask_b32 v170, v156, v152, vcc
    v_cndmask_b32 v171, v157, v153, vcc
.Lw2_8:
    v_lshrrev_b32 v160, 5, v1
    v_sub_u32 v160, s57, v160
    v_add_u32 v160, -1, v160
    v_and_b32 v161, 31, v1
    s_add_u32 m0, s94, 0
    s_add_u32 s68, s69, 512
    v_lshlrev_b32 v161, 4, v161
    v_mov_b32 v163, s100
    v_add_u32 v162, 0, v160
    v_cmp_le_i32 vcc, 0, v162
    buffer_load_dwordx4 v240, s[12:15], s68 offen offset:0  lds
    v_lshl_add_u32 v162, v162, 10, v161
    v_cndmask_b32 v144, v3, v162, vcc
    v_cndmask_b32 v152, 0, v163, vcc
    buffer_load_dwordx4 v241, s[12:15], s68 offen offset:1024  lds
    v_add_u32 v162, -2, v160
    v_cmp_le_i32 vcc, 0, v162
    v_lshl_add_u32 v162, v162, 10, v161
    s_nop 0
    v_cndmask_b32 v145, v3, v162, vcc
    buffer_load_dwordx4 v242, s[12:15], s68 offen offset:2048  lds
    v_cndmask_b32 v153, 0, v163, vcc
    v_add_u32 v162, -4, v160
    v_cmp_le_i32 vcc, 0, v162
    buffer_load_dwordx4 v243, s[12:15], s68 offen offset:3072  lds
    s_add_u32 m0, s94, 4096
    s_add_u32 s68, s69, 131584
    v_lshl_add_u32 v162, v162, 10, v161
    v_cndmask_b32 v146, v3, v162, vcc
    v_cndmask_b32 v154, 0, v163, vcc
    v_add_u32 v162, -6, v160
    buffer_load_dwordx4 v240, s[12:15], s68 offen offset:0  lds
    v_cmp_le_i32 vcc, 0, v162
    v_lshl_add_u32 v162, v162, 10, v161
    s_nop 0
    v_cndmask_b32 v147, v3, v162, vcc
    v_cndmask_b32 v155, 0, v163, vcc
    buffer_load_dwordx4 v241, s[12:15], s68 offen offset:1024  lds
    v_add_u32 v162, -8, v160
    v_cmp_le_i32 vcc, 0, v162
    v_lshl_add_u32 v162, v162, 10, v161
    buffer_load_dwordx4 v242, s[12:15], s68 offen offset:2048  lds
    v_cndmask_b32 v148, v3, v162, vcc
    v_cndmask_b32 v156, 0, v163, vcc
    v_add_u32 v162, -10, v160
    v_cmp_le_i32 vcc, 0, v162
    buffer_load_dwordx4 v243, s[12:15], s68 offen offset:3072  lds
    v_lshl_add_u32 v162, v162, 10, v161
    v_cndmask_b32 v149, v3, v162, vcc
    v_cndmask_b32 v157, 0, v163, vcc
    v_add_u32 v248, s90, v244
    v_add_u32 v249, s90, v245
    v_add_u32 v250, s90, v246
    v_add_u32 v251, s90, v247
    s_waitcnt vmcnt(39)
    v_add_u32 v162, -12, v160
    v_cmp_le_i32 vcc, 0, v162
    v_lshl_add_u32 v162, v162, 10, v161
    s_nop 0
    v_cndmask_b32 v150, v3, v162, vcc
    ds_read_b128 a[0:3], v248 offset:0
    v_xor_b32 v248, 4096, v248
    v_cndmask_b32 v158, 0, v163, vcc
    v_add_u32 v162, -14, v160
    v_cmp_le_i32 vcc, 0, v162
    v_lshl_add_u32 v162, v162, 10, v161
    ds_read_b128 a[8:11], v249 offset:0
    v_xor_b32 v249, 4096, v249
    v_cndmask_b32 v151, v3, v162, vcc
    v_cndmask_b32 v159, 0, v163, vcc
    s_lshr_b32 s60, s56, 1
    ds_read_b128 a[16:19], v250 offset:0
    v_xor_b32 v250, 4096, v250
    s_mul_i32 s77, s60, 81920
    v_bfe_u32 v184, v1, 4, 1
    v_xor_b32 v184, s60, v184
    v_lshlrev_b32 v184, 4, v184
    ds_read_b128 a[24:27], v251 offset:0
    v_xor_b32 v251, 4096, v251
    v_bfe_u32 v185, v1, 2, 1
    v_lshl_add_u32 v184, v185, 3, v184
    v_bfe_u32 v185, v1, 3, 1
    ds_read_b128 a[4:7], v248 offset:0
    v_lshl_add_u32 v184, v185, 2, v184
    v_and_b32 v185, 35, v1
    v_add_lshl_u32 v184, v184, v185, 4
    v_add_u32 v236, s77, v184
    ds_read_b128 a[12:15], v249 offset:0
    s_lshl_b32 s61, s3, 2
    s_add_u32 s61, s61, s60
    s_lshl_b32 s60, s81, 1
    s_add_u32 s61, s61, s60
    ds_read_b128 a[20:23], v250 offset:0
    s_lshl_b32 s61, s61, 4
    s_and_b32 s60, s56, 1
    s_add_u32 s95, s61, s60
    ds_read_b128 a[28:31], v251 offset:0
    s_mul_i32 s95, s95, 6144
    s_add_u32 s95, s95, 1048576
    s_mul_i32 s60, s60, 6144
    s_add_u32 s77, s77, s60
    v_add_u32 v248, s91, v244
    v_add_u32 v249, s91, v245
    v_add_u32 v250, s91, v246
    v_add_u32 v251, s91, v247
    s_waitcnt vmcnt(31) lgkmcnt(7)
    s_lshl_b32 s61, s61, 7
    s_add_u32 s61, s61, 14680064
    v_mov_b32 v238, v3
    ds_read_b128 a[32:35], v248 offset:0
    v_xor_b32 v248, 4096, v248
    s_sub_u32 s61, s61, 0
    v_lshl_add_u32 v239, v1, 7, s61
    s_mov_b32 vcc_lo, 65535
    s_mov_b32 vcc_hi, 0
    ds_read_b128 a[40:43], v249 offset:0
    v_xor_b32 v249, 4096, v249
    v_cndmask_b32 v238, v238, v239, vcc
    s_lshr_b32 s60, s59, 1
    s_lshl_b32 s60, s60, 9
    s_add_u32 s60, s60, 14680064
    ds_read_b128 a[48:51], v250 offset:0
    v_xor_b32 v250, 4096, v250
    v_add_u32 v184, 16, v1
    v_bfe_u32 v184, v184, 2, 3
    v_lshlrev_b32 v184, 13, v184
    ds_read_b128 a[56:59], v251 offset:0
    v_xor_b32 v251, 4096, v251
    v_and_b32 v185, 3, v1
    v_lshl_add_u32 v184, v185, 7, v184
    v_add_u32 v184, s60, v184
    s_mov_b32 vcc_lo, 0xffff0000
    ds_read_b128 a[36:39], v248 offset:0
    s_mov_b32 vcc_hi, 0xffff
    v_cndmask_b32 v238, v238, v184, vcc
    s_lshr_b32 s60, s59, 1
    ds_read_b128 a[44:47], v249 offset:0
    s_lshl_b32 s60, s60, 1
    s_and_b32 s61, s56, 1
    s_add_u32 s60, s60, s61
    s_lshl_b32 s60, s60, 1
    ds_read_b128 a[52:55], v250 offset:0
    s_add_u32 s60, s60, s81
    s_lshl_b32 s61, s3, 6
    s_add_u32 s72, s60, s61
    ds_read_b128 a[60:63], v251 offset:0
    buffer_load_dwordx4 v[80:83], v144, s[16:19], s62 offen sc1
    buffer_load_dwordx4 v[84:87], v145, s[16:19], s62 offen sc1
    buffer_load_dwordx4 v[88:91], v146, s[16:19], s62 offen sc1
    buffer_load_dwordx4 v[92:95], v147, s[16:19], s62 offen sc1
    buffer_load_dwordx4 v[96:99], v148, s[16:19], s62 offen sc1
    buffer_load_dwordx4 v[100:103], v149, s[16:19], s62 offen sc1
    buffer_load_dwordx4 v[104:107], v150, s[16:19], s62 offen sc1
    buffer_load_dwordx4 v[108:111], v151, s[16:19], s62 offen sc1
    s_waitcnt lgkmcnt(0)
    s_add_u32 m0, s90, 0
    s_add_u32 s68, s69, 640
    buffer_load_dwordx4 v240, s[12:15], s68 offen offset:0  lds
    buffer_load_dwordx4 v241, s[12:15], s68 offen offset:1024  lds
    buffer_load_dwordx4 v242, s[12:15], s68 offen offset:2048  lds
    buffer_load_dwordx4 v243, s[12:15], s68 offen offset:3072  lds
    s_add_u32 m0, s90, 4096
    s_add_u32 s68, s69, 131712
    buffer_load_dwordx4 v240, s[12:15], s68 offen offset:0  lds
    buffer_load_dwordx4 v241, s[12:15], s68 offen offset:1024  lds
    buffer_load_dwordx4 v242, s[12:15], s68 offen offset:2048  lds
    buffer_load_dwordx4 v243, s[12:15], s68 offen offset:3072  lds
    s_add_u32 m0, s91, 0
    s_add_u32 s68, s69, 768
    buffer_load_dwordx4 v240, s[12:15], s68 offen offset:0  lds
    buffer_load_dwordx4 v241, s[12:15], s68 offen offset:1024  lds
    buffer_load_dwordx4 v242, s[12:15], s68 offen offset:2048  lds
    buffer_load_dwordx4 v243, s[12:15], s68 offen offset:3072  lds
    s_add_u32 m0, s91, 4096
    s_add_u32 s68, s69, 131840
    buffer_load_dwordx4 v240, s[12:15], s68 offen offset:0  lds
    buffer_load_dwordx4 v241, s[12:15], s68 offen offset:1024  lds
    buffer_load_dwordx4 v242, s[12:15], s68 offen offset:2048  lds
    buffer_load_dwordx4 v243, s[12:15], s68 offen offset:3072  lds
    s_waitcnt vmcnt(16)
    s_mov_b32 s99, 0
.Lep_9:
    v_mov_b32 v160, 0
    v_xor_b32 v161, v152, v81
    v_xor_b32 v162, v152, v83
    v_or3_b32 v160, v160, v161, v162
    v_xor_b32 v161, v153, v85
    v_xor_b32 v162, v153, v87
    v_or3_b32 v160, v160, v161, v162
    v_xor_b32 v161, v154, v89
    v_xor_b32 v162, v154, v91
    v_or3_b32 v160, v160, v161, v162
    v_xor_b32 v161, v155, v93
    v_xor_b32 v162, v155, v95
    v_or3_b32 v160, v160, v161, v162
    v_xor_b32 v161, v156, v97
    v_xor_b32 v162, v156, v99
    v_or3_b32 v160, v160, v161, v162
    v_xor_b32 v161, v157, v101
    v_xor_b32 v162, v157, v103
    v_or3_b32 v160, v160, v161, v162
    v_xor_b32 v161, v158, v105
    v_xor_b32 v162, v158, v107
    v_or3_b32 v160, v160, v161, v162
    v_xor_b32 v161, v159, v109
    v_xor_b32 v162, v159, v111
    v_or3_b32 v160, v160, v161, v162
    v_cmp_ne_u32 vcc, 0, v160
    s_nop 0
    s_cmp_eq_u64 vcc, 0
    s_cbranch_scc1 .Led_10
    buffer_load_dwordx4 v[80:83], v144, s[16:19], s62 offen sc1
    buffer_load_dwordx4 v[84:87], v145, s[16:19], s62 offen sc1
    buffer_load_dwordx4 v[88:91], v146, s[16:19], s62 offen sc1
    buffer_load_dwordx4 v[92:95], v147, s[16:19], s62 offen sc1
    buffer_load_dwordx4 v[96:99], v148, s[16:19], s62 offen sc1
    buffer_load_dwordx4 v[100:103], v149, s[16:19], s62 offen sc1
    buffer_load_dwordx4 v[104:107], v150, s[16:19], s62 offen sc1
    buffer_load_dwordx4 v[108:111], v151, s[16:19], s62 offen sc1
    s_waitcnt vmcnt(0)
    s_add_u32 s99, s99, 1
    s_cmp_lt_u32 s99, 200000
    s_cbranch_scc1 .Lep_9
.Led_10:
    v_mov_b32 v178, s100
    v_mov_b32 v179, v3
    v_writelane_b32 v179, 0, 0
    s_lshl_b32 s60, s58, 6
    s_lshl_b32 s61, s57, 2
    s_add_u32 s60, s60, s61
    s_add_u32 s60, s60, s56
    s_lshl_b32 s60, s60, 7
    s_add_u32 s60, s60, 14942208
    buffer_store_dword v178, v179, s[16:19], s60 offen sc1
    s_lshl_b32 s60, s63, 3
    s_add_u32 s60, s60, s58
    s_lshl_b32 s60, s60, 14
    s_lshl_b32 s61, s89, 12
    s_add_u32 s60, s60, s61
    v_add_u32 v248, s92, v244
    v_add_u32 v249, s92, v245
    v_add_u32 v250, s92, v246
    v_add_u32 v251, s92, v247
    s_add_u32 s73, s60, 10485760
    s_add_u32 s74, s73, 8192
    v_lshrrev_b32 v136, 5, v1
    v_lshlrev_b32 v136, 11, v136
    ds_read_b128 a[64:67], v248 offset:0
    v_xor_b32 v248, 4096, v248
    v_and_b32 v137, 31, v1
    v_lshl_add_u32 v132, v137, 4, v136
    v_xor_b32 v133, 64, v132
    v_xor_b32 v134, 128, v132
    ds_read_b128 a[72:75], v249 offset:0
    v_xor_b32 v249, 4096, v249
    v_xor_b32 v135, 192, v132
    v_mov_b32 v81, v82
    v_mov_b32 v85, v86
    v_mov_b32 v89, v90
    ds_read_b128 a[80:83], v250 offset:0
    v_xor_b32 v250, 4096, v250
    v_mov_b32 v93, v94
    v_mov_b32 v97, v98
    v_mov_b32 v101, v102
    v_mov_b32 v105, v106
    v_mov_b32 v109, v110
    ds_read_b128 a[88:91], v251 offset:0
    v_xor_b32 v251, 4096, v251
    v_fma_f32 v232, v226, v108, v104
    v_fma_f32 v233, v226, v109, v105
    v_fma_f32 v232, -v227, v109, v232
    v_fma_f32 v109, v227, v108, v233
    ds_read_b128 a[68:71], v248 offset:0
    v_mov_b32 v108, v232
    v_fma_f32 v232, v226, v108, v100
    v_fma_f32 v233, v226, v109, v101
    v_fma_f32 v232, -v227, v109, v232
    ds_read_b128 a[76:79], v249 offset:0
    v_fma_f32 v109, v227, v108, v233
    v_mov_b32 v108, v232
    v_fma_f32 v232, v226, v108, v96
    v_fma_f32 v233, v226, v109, v97
    ds_read_b128 a[84:87], v250 offset:0
    v_fma_f32 v232, -v227, v109, v232
    v_fma_f32 v109, v227, v108, v233
    v_mov_b32 v108, v232
    v_fma_f32 v232, v226, v108, v92
    ds_read_b128 a[92:95], v251 offset:0
    v_fma_f32 v233, v226, v109, v93
    v_fma_f32 v232, -v227, v109, v232
    v_fma_f32 v109, v227, v108, v233
    v_mov_b32 v108, v232
    v_fma_f32 v232, v226, v108, v88
    s_waitcnt lgkmcnt(0)
    v_fma_f32 v233, v226, v109, v89
    v_fma_f32 v232, -v227, v109, v232
    v_fma_f32 v109, v227, v108, v233
    v_mov_b32 v108, v232
    s_add_u32 m0, s92, 0
    s_add_u32 s68, s69, 896
    v_fma_f32 v232, v226, v108, v84
    v_fma_f32 v233, v226, v109, v85
    v_fma_f32 v232, -v227, v109, v232
    v_fma_f32 v109, v227, v108, v233
    buffer_load_dwordx4 v240, s[12:15], s68 offen offset:0  lds
    v_mov_b32 v108, v232
    v_fma_f32 v232, v226, v108, v80
    v_fma_f32 v233, v226, v109, v81
    v_fma_f32 v232, -v227, v109, v232
    buffer_load_dwordx4 v241, s[12:15], s68 offen offset:1024  lds
    v_fma_f32 v109, v227, v108, v233
    v_mov_b32 v108, v232
    v_mov_b32 v160, v108
    v_mov_b32 v161, v109
    buffer_load_dwordx4 v242, s[12:15], s68 offen offset:2048  lds
    v_permlane32_swap_b32 v108, v160
    v_permlane32_swap_b32 v109, v161
    v_fma_f32 v232, v224, v160, v108
    v_fma_f32 v233, v224, v161, v109
    v_fma_f32 v232, -v225, v161, v232
    buffer_load_dwordx4 v243, s[12:15], s68 offen offset:3072  lds
    s_add_u32 m0, s92, 4096
    s_add_u32 s68, s69, 131968
    v_fma_f32 v109, v225, v160, v233
    v_mov_b32 v108, v232
    v_fma_f32 v232, v228, v108, v168
    v_fma_f32 v233, v228, v109, v169
    buffer_load_dwordx4 v240, s[12:15], s68 offen offset:0  lds
    v_fma_f32 v232, -v229, v109, v232
    v_fma_f32 v169, v229, v108, v233
    v_mov_b32 v168, v232
    v_fma_f32 v232, v230, v108, v170
    buffer_load_dwordx4 v241, s[12:15], s68 offen offset:1024  lds
    v_fma_f32 v233, v230, v109, v171
    v_fma_f32 v232, -v231, v109, v232
    v_fma_f32 v171, v231, v108, v233
    v_mov_b32 v170, v232
    buffer_load_dwordx4 v242, s[12:15], s68 offen offset:2048  lds
    v_mov_b32 v128, v168
    v_mov_b32 v129, v170
    v_mov_b32 v130, v169
    v_mov_b32 v131, v171
    buffer_load_dwordx4 v243, s[12:15], s68 offen offset:3072  lds
    v_pk_fma_f32 v[136:137], v[218:219], v[128:129], v[16:17] op_sel_hi:[0,1,1]
    v_pk_fma_f32 v[138:139], v[218:219], v[130:131], v[32:33] op_sel_hi:[0,1,1]
    v_pk_fma_f32 v[16:17], v[218:219], v[130:131], v[136:137] op_sel:[1,0,0] op_sel_hi:[1,1,1] neg_lo:[1,0,0] neg_hi:[1,0,0]
    v_pk_fma_f32 v[32:33], v[218:219], v[128:129], v[138:139] op_sel:[1,0,0] op_sel_hi:[1,1,1]
    v_pk_mul_f32 v[144:145], v[220:221], v[16:17] op_sel_hi:[0,1]
    v_pk_mul_f32 v[146:147], v[220:221], v[32:33] op_sel_hi:[0,1] neg_lo:[1,0] neg_hi:[1,0]
    v_pk_fma_f32 v[144:145], v[220:221], v[32:33], v[144:145] op_sel:[1,0,0] op_sel_hi:[1,1,1] neg_lo:[1,0,0] neg_hi:[1,0,0]
    v_pk_fma_f32 v[146:147], v[220:221], v[16:17], v[146:147] op_sel:[1,0,0] op_sel_hi:[1,1,1] neg_lo:[1,0,0] neg_hi:[1,0,0]
    v_pk_fma_f32 v[136:137], v[218:219], v[16:17], v[18:19] op_sel_hi:[0,1,1]
    v_add_u32 v248, s93, v244
    v_add_u32 v249, s93, v245
    v_add_u32 v250, s93, v246
    v_add_u32 v251, s93, v247
    v_pk_fma_f32 v[138:139], v[218:219], v[32:33], v[34:35] op_sel_hi:[0,1,1]
    v_pk_fma_f32 v[18:19], v[218:219], v[32:33], v[136:137] op_sel:[1,0,0] op_sel_hi:[1,1,1] neg_lo:[1,0,0] neg_hi:[1,0,0]
    v_pk_fma_f32 v[34:35], v[218:219], v[16:17], v[138:139] op_sel:[1,0,0] op_sel_hi:[1,1,1]
    v_pk_mul_f32 v[148:149], v[220:221], v[18:19] op_sel_hi:[0,1]
    v_pk_mul_f32 v[150:151], v[220:221], v[34:35] op_sel_hi:[0,1] neg_lo:[1,0] neg_hi:[1,0]
    v_pk_fma_f32 v[148:149], v[220:221], v[34:35], v[148:149] op_sel:[1,0,0] op_sel_hi:[1,1,1] neg_lo:[1,0,0] neg_hi:[1,0,0]
    v_pk_fma_f32 v[150:151], v[220:221], v[18:19], v[150:151] op_sel:[1,0,0] op_sel_hi:[1,1,1] neg_lo:[1,0,0] neg_hi:[1,0,0]
    v_cvt_pk_bf16_f32 v80, v144, v148
    v_cvt_pk_bf16_f32 v88, v145, v149
    ds_read_b128 a[96:99], v248 offset:0
    v_xor_b32 v248, 4096, v248
    v_cvt_pk_bf16_f32 v96, v146, v150
    v_cvt_pk_bf16_f32 v104, v147, v151
    v_pk_fma_f32 v[136:137], v[218:219], v[18:19], v[20:21] op_sel_hi:[0,1,1]
    v_pk_fma_f32 v[138:139], v[218:219], v[34:35], v[36:37] op_sel_hi:[0,1,1]
    v_pk_fma_f32 v[20:21], v[218:219], v[34:35], v[136:137] op_sel:[1,0,0] op_sel_hi:[1,1,1] neg_lo:[1,0,0] neg_hi:[1,0,0]
    v_pk_fma_f32 v[36:37], v[218:219], v[18:19], v[138:139] op_sel:[1,0,0] op_sel_hi:[1,1,1]
    v_pk_mul_f32 v[152:153], v[220:221], v[20:21] op_sel_hi:[0,1]
    v_pk_mul_f32 v[154:155], v[220:221], v[36:37] op_sel_hi:[0,1] neg_lo:[1,0] neg_hi:[1,0]
    v_pk_fma_f32 v[152:153], v[220:221], v[36:37], v[152:153] op_sel:[1,0,0] op_sel_hi:[1,1,1] neg_lo:[1,0,0] neg_hi:[1,0,0]
    ds_read_b128 a[104:107], v249 offset:0
    v_xor_b32 v249, 4096, v249
    v_pk_fma_f32 v[154:155], v[220:221], v[20:21], v[154:155] op_sel:[1,0,0] op_sel_hi:[1,1,1] neg_lo:[1,0,0] neg_hi:[1,0,0]
    v_pk_fma_f32 v[136:137], v[218:219], v[20:21], v[22:23] op_sel_hi:[0,1,1]
    v_pk_fma_f32 v[138:139], v[218:219], v[36:37], v[38:39] op_sel_hi:[0,1,1]
    v_pk_fma_f32 v[22:23], v[218:219], v[36:37], v[136:137] op_sel:[1,0,0] op_sel_hi:[1,1,1] neg_lo:[1,0,0] neg_hi:[1,0,0]
    v_pk_fma_f32 v[38:39], v[218:219], v[20:21], v[138:139] op_sel:[1,0,0] op_sel_hi:[1,1,1]
    v_pk_mul_f32 v[156:157], v[220:221], v[22:23] op_sel_hi:[0,1]
    v_pk_mul_f32 v[158:159], v[220:221], v[38:39] op_sel_hi:[0,1] neg_lo:[1,0] neg_hi:[1,0]
    v_pk_fma_f32 v[156:157], v[220:221], v[38:39], v[156:157] op_sel:[1,0,0] op_sel_hi:[1,1,1] neg_lo:[1,0,0] neg_hi:[1,0,0]
    v_pk_fma_f32 v[158:159], v[220:221], v[22:23], v[158:159] op_sel:[1,0,0] op_sel_hi:[1,1,1] neg_lo:[1,0,0] neg_hi:[1,0,0]
    ds_read_b128 a[112:115], v250 offset:0
    v_xor_b32 v250, 4096, v250
    v_cvt_pk_bf16_f32 v81, v152, v156
    v_cvt_pk_bf16_f32 v89, v153, v157
    v_cvt_pk_bf16_f32 v97, v154, v158
    v_cvt_pk_bf16_f32 v105, v155, v159
    v_pk_fma_f32 v[136:137], v[218:219], v[22:23], v[24:25] op_sel_hi:[0,1,1]
    v_pk_fma_f32 v[138:139], v[218:219], v[38:39], v[40:41] op_sel_hi:[0,1,1]
    v_pk_fma_f32 v[24:25], v[218:219], v[38:39], v[136:137] op_sel:[1,0,0] op_sel_hi:[1,1,1] neg_lo:[1,0,0] neg_hi:[1,0,0]
    v_pk_fma_f32 v[40:41], v[218:219], v[22:23], v[138:139] op_sel:[1,0,0] op_sel_hi:[1,1,1]
    v_pk_mul_f32 v[144:145], v[220:221], v[24:25] op_sel_hi:[0,1]
    ds_read_b128 a[120:123], v251 offset:0
    v_xor_b32 v251, 4096, v251
    v_pk_mul_f32 v[146:147], v[220:221], v[40:41] op_sel_hi:[0,1] neg_lo:[1,0] neg_hi:[1,0]
    v_pk_fma_f32 v[144:145], v[220:221], v[40:41], v[144:145] op_sel:[1,0,0] op_sel_hi:[1,1,1] neg_lo:[1,0,0] neg_hi:[1,0,0]
    v_pk_fma_f32 v[146:147], v[220:221], v[24:25], v[146:147] op_sel:[1,0,0] op_sel_hi:[1,1,1] neg_lo:[1,0,0] neg_hi:[1,0,0]
    v_pk_fma_f32 v[136:137], v[218:219], v[24:25], v[26:27] op_sel_hi:[0,1,1]
    v_pk_fma_f32 v[138:139], v[218:219], v[40:41], v[42:43] op_sel_hi:[0,1,1]
    v_pk_fma_f32 v[26:27], v[218:219], v[40:41], v[136:137] op_sel:[1,0,0] op_sel_hi:[1,1,1] neg_lo:[1,0,0] neg_hi:[1,0,0]
    v_pk_fma_f32 v[42:43], v[218:219], v[24:25], v[138:139] op_sel:[1,0,0] op_sel_hi:[1,1,1]
    v_pk_mul_f32 v[148:149], v[220:221], v[26:27] op_sel_hi:[0,1]
    v_pk_mul_f32 v[150:151], v[220:221], v[42:43] op_sel_hi:[0,1] neg_lo:[1,0] neg_hi:[1,0]
    ds_read_b128 a[100:103], v248 offset:0
    v_pk_fma_f32 v[148:149], v[220:221], v[42:43], v[148:149] op_sel:[1,0,0] op_sel_hi:[1,1,1] neg_lo:[1,0,0] neg_hi:[1,0,0]
    v_pk_fma_f32 v[150:151], v[220:221], v[26:27], v[150:151] op_sel:[1,0,0] op_sel_hi:[1,1,1] neg_lo:[1,0,0] neg_hi:[1,0,0]
    v_cvt_pk_bf16_f32 v82, v144, v148
    v_cvt_pk_bf16_f32 v90, v145, v149
    v_cvt_pk_bf16_f32 v98, v146, v150
    v_cvt_pk_bf16_f32 v106, v147, v151
    v_pk_fma_f32 v[136:137], v[218:219], v[26:27], v[28:29] op_sel_hi:[0,1,1]
    v_pk_fma_f32 v[138:139], v[218:219], v[42:43], v[44:45] op_sel_hi:[0,1,1]
    v_pk_fma_f32 v[28:29], v[218:219], v[42:43], v[136:137] op_sel:[1,0,0] op_sel_hi:[1,1,1] neg_lo:[1,0,0] neg_hi:[1,0,0]
    ds_read_b128 a[108:111], v249 offset:0
    v_pk_fma_f32 v[44:45], v[218:219], v[26:27], v[138:139] op_sel:[1,0,0] op_sel_hi:[1,1,1]
    v_pk_mul_f32 v[152:153], v[220:221], v[28:29] op_sel_hi:[0,1]
    v_pk_mul_f32 v[154:155], v[220:221], v[44:45] op_sel_hi:[0,1] neg_lo:[1,0] neg_hi:[1,0]
    v_pk_fma_f32 v[152:153], v[220:221], v[44:45], v[152:153] op_sel:[1,0,0] op_sel_hi:[1,1,1] neg_lo:[1,0,0] neg_hi:[1,0,0]
    v_pk_fma_f32 v[154:155], v[220:221], v[28:29], v[154:155] op_sel:[1,0,0] op_sel_hi:[1,1,1] neg_lo:[1,0,0] neg_hi:[1,0,0]
    v_pk_fma_f32 v[136:137], v[218:219], v[28:29], v[30:31] op_sel_hi:[0,1,1]
    v_pk_fma_f32 v[138:139], v[218:219], v[44:45], v[46:47] op_sel_hi:[0,1,1]
    v_pk_fma_f32 v[30:31], v[218:219], v[44:45], v[136:137] op_sel:[1,0,0] op_sel_hi:[1,1,1] neg_lo:[1,0,0] neg_hi:[1,0,0]
    v_pk_fma_f32 v[46:47], v[218:219], v[28:29], v[138:139] op_sel:[1,0,0] op_sel_hi:[1,1,1]
    ds_read_b128 a[116:119], v250 offset:0
    v_pk_mul_f32 v[156:157], v[220:221], v[30:31] op_sel_hi:[0,1]
    v_pk_mul_f32 v[158:159], v[220:221], v[46:47] op_sel_hi:[0,1] neg_lo:[1,0] neg_hi:[1,0]
    v_pk_fma_f32 v[156:157], v[220:221], v[46:47], v[156:157] op_sel:[1,0,0] op_sel_hi:[1,1,1] neg_lo:[1,0,0] neg_hi:[1,0,0]
    v_pk_fma_f32 v[158:159], v[220:221], v[30:31], v[158:159] op_sel:[1,0,0] op_sel_hi:[1,1,1] neg_lo:[1,0,0] neg_hi:[1,0,0]
    v_cvt_pk_bf16_f32 v83, v152, v156
    v_cvt_pk_bf16_f32 v91, v153, v157
    v_cvt_pk_bf16_f32 v99, v154, v158
    v_cvt_pk_bf16_f32 v107, v155, v159
    ds_read_b128 a[124:127], v251 offset:0
    buffer_load_dword v239, v238, s[16:19], 0 offen sc1
    v_pk_fma_f32 v[136:137], v[218:219], v[30:31], v[48:49] op_sel_hi:[0,1,1]
    v_pk_fma_f32 v[138:139], v[218:219], v[46:47], v[64:65] op_sel_hi:[0,1,1]
    v_pk_fma_f32 v[48:49], v[218:219], v[46:47], v[136:137] op_sel:[1,0,0] op_sel_hi:[1,1,1] neg_lo:[1,0,0] neg_hi:[1,0,0]
    v_pk_fma_f32 v[64:65], v[218:219], v[30:31], v[138:139] op_sel:[1,0,0] op_sel_hi:[1,1,1]
    v_pk_mul_f32 v[144:145], v[220:221], v[48:49] op_sel_hi:[0,1]
    v_add_u32 v248, s94, v244
    v_add_u32 v249, s94, v245
    v_add_u32 v250, s94, v246
    v_add_u32 v251, s94, v247
    s_waitcnt lgkmcnt(7)
    v_pk_mul_f32 v[146:147], v[220:221], v[64:65] op_sel_hi:[0,1] neg_lo:[1,0] neg_hi:[1,0]
    v_pk_fma_f32 v[144:145], v[220:221], v[64:65], v[144:145] op_sel:[1,0,0] op_sel_hi:[1,1,1] neg_lo:[1,0,0] neg_hi:[1,0,0]
    v_pk_fma_f32 v[146:147], v[220:221], v[48:49], v[146:147] op_sel:[1,0,0] op_sel_hi:[1,1,1] neg_lo:[1,0,0] neg_hi:[1,0,0]
    v_pk_fma_f32 v[136:137], v[218:219], v[48:49], v[50:51] op_sel_hi:[0,1,1]
    v_pk_fma_f32 v[138:139], v[218:219], v[64:65], v[66:67] op_sel_hi:[0,1,1]
    ds_read_b128 a[128:131], v248 offset:0
    v_xor_b32 v248, 4096, v248
    v_pk_fma_f32 v[50:51], v[218:219], v[64:65], v[136:137] op_sel:[1,0,0] op_sel_hi:[1,1,1] neg_lo:[1,0,0] neg_hi:[1,0,0]
    v_pk_fma_f32 v[66:67], v[218:219], v[48:49], v[138:139] op_sel:[1,0,0] op_sel_hi:[1,1,1]
    v_pk_mul_f32 v[148:149], v[220:221], v[50:51] op_sel_hi:[0,1]
    v_pk_mul_f32 v[150:151], v[220:221], v[66:67] op_sel_hi:[0,1] neg_lo:[1,0] neg_hi:[1,0]
    ds_read_b128 a[136:139], v249 offset:0
    v_xor_b32 v249, 4096, v249
    v_pk_fma_f32 v[148:149], v[220:221], v[66:67], v[148:149] op_sel:[1,0,0] op_sel_hi:[1,1,1] neg_lo:[1,0,0] neg_hi:[1,0,0]
    v_pk_fma_f32 v[150:151], v[220:221], v[50:51], v[150:151] op_sel:[1,0,0] op_sel_hi:[1,1,1] neg_lo:[1,0,0] neg_hi:[1,0,0]
    v_cvt_pk_bf16_f32 v84, v144, v148
    v_cvt_pk_bf16_f32 v92, v145, v149
    v_cvt_pk_bf16_f32 v100, v146, v150
    ds_read_b128 a[144:147], v250 offset:0
    v_xor_b32 v250, 4096, v250
    v_cvt_pk_bf16_f32 v108, v147, v151
    buffer_store_dwordx4 v[80:83], v132, s[16:19], s73 offen offset:0 sc1
    v_pk_fma_f32 v[136:137], v[218:219], v[50:51], v[52:53] op_sel_hi:[0,1,1]
    v_pk_fma_f32 v[138:139], v[218:219], v[66:67], v[68:69] op_sel_hi:[0,1,1]
    v_pk_fma_f32 v[52:53], v[218:219], v[66:67], v[136:137] op_sel:[1,0,0] op_sel_hi:[1,1,1] neg_lo:[1,0,0] neg_hi:[1,0,0]
    ds_read_b128 a[152:155], v251 offset:0
    v_xor_b32 v251, 4096, v251
    v_pk_fma_f32 v[68:69], v[218:219], v[50:51], v[138:139] op_sel:[1,0,0] op_sel_hi:[1,1,1]
    v_pk_mul_f32 v[152:153], v[220:221], v[52:53] op_sel_hi:[0,1]
    v_pk_mul_f32 v[154:155], v[220:221], v[68:69] op_sel_hi:[0,1] neg_lo:[1,0] neg_hi:[1,0]
    v_pk_fma_f32 v[152:153], v[220:221], v[68:69], v[152:153] op_sel:[1,0,0] op_sel_hi:[1,1,1] neg_lo:[1,0,0] neg_hi:[1,0,0]
    ds_read_b128 a[132:135], v248 offset:0
    v_pk_fma_f32 v[154:155], v[220:221], v[52:53], v[154:155] op_sel:[1,0,0] op_sel_hi:[1,1,1] neg_lo:[1,0,0] neg_hi:[1,0,0]
    v_pk_fma_f32 v[136:137], v[218:219], v[52:53], v[54:55] op_sel_hi:[0,1,1]
    v_pk_fma_f32 v[138:139], v[218:219], v[68:69], v[70:71] op_sel_hi:[0,1,1]
    v_pk_fma_f32 v[54:55], v[218:219], v[68:69], v[136:137] op_sel:[1,0,0] op_sel_hi:[1,1,1] neg_lo:[1,0,0] neg_hi:[1,0,0]
    v_pk_fma_f32 v[70:71], v[218:219], v[52:53], v[138:139] op_sel:[1,0,0] op_sel_hi:[1,1,1]
    ds_read_b128 a[140:143], v249 offset:0
    v_pk_mul_f32 v[156:157], v[220:221], v[54:55] op_sel_hi:[0,1]
    v_pk_mul_f32 v[158:159], v[220:221], v[70:71] op_sel_hi:[0,1] neg_lo:[1,0] neg_hi:[1,0]
    v_pk_fma_f32 v[156:157], v[220:221], v[70:71], v[156:157] op_sel:[1,0,0] op_sel_hi:[1,1,1] neg_lo:[1,0,0] neg_hi:[1,0,0]
    v_pk_fma_f32 v[158:159], v[220:221], v[54:55], v[158:159] op_sel:[1,0,0] op_sel_hi:[1,1,1] neg_lo:[1,0,0] neg_hi:[1,0,0]
    v_cvt_pk_bf16_f32 v85, v152, v156
    ds_read_b128 a[148:151], v250 offset:0
    v_cvt_pk_bf16_f32 v93, v153, v157
    v_cvt_pk_bf16_f32 v101, v154, v158
    v_cvt_pk_bf16_f32 v109, v155, v159
    buffer_store_dwordx4 v[96:99], v132, s[16:19], s74 offen offset:0 sc1
    ds_read_b128 a[156:159], v251 offset:0
    v_pk_fma_f32 v[136:137], v[218:219], v[54:55], v[56:57] op_sel_hi:[0,1,1]
    v_pk_fma_f32 v[138:139], v[218:219], v[70:71], v[72:73] op_sel_hi:[0,1,1]
    v_pk_fma_f32 v[56:57], v[218:219], v[70:71], v[136:137] op_sel:[1,0,0] op_sel_hi:[1,1,1] neg_lo:[1,0,0] neg_hi:[1,0,0]
    v_pk_fma_f32 v[72:73], v[218:219], v[54:55], v[138:139] op_sel:[1,0,0] op_sel_hi:[1,1,1]
    v_pk_mul_f32 v[144:145], v[220:221], v[56:57] op_sel_hi:[0,1]
    v_add_u32 v248, s90, v244
    v_add_u32 v249, s90, v245
    v_add_u32 v250, s90, v246
    v_add_u32 v251, s90, v247
    s_waitcnt vmcnt(20) lgkmcnt(7)
    v_pk_mul_f32 v[146:147], v[220:221], v[72:73] op_sel_hi:[0,1] neg_lo:[1,0] neg_hi:[1,0]
    v_pk_fma_f32 v[144:145], v[220:221], v[72:73], v[144:145] op_sel:[1,0,0] op_sel_hi:[1,1,1] neg_lo:[1,0,0] neg_hi:[1,0,0]
    v_pk_fma_f32 v[146:147], v[220:221], v[56:57], v[146:147] op_sel:[1,0,0] op_sel_hi:[1,1,1] neg_lo:[1,0,0] neg_hi:[1,0,0]
    v_pk_fma_f32 v[136:137], v[218:219], v[56:57], v[58:59] op_sel_hi:[0,1,1]
    v_pk_fma_f32 v[138:139], v[218:219], v[72:73], v[74:75] op_sel_hi:[0,1,1]
    ds_read_b128 a[160:163], v248 offset:0
    v_xor_b32 v248, 4096, v248
    v_pk_fma_f32 v[58:59], v[218:219], v[72:73], v[136:137] op_sel:[1,0,0] op_sel_hi:[1,1,1] neg_lo:[1,0,0] neg_hi:[1,0,0]
    v_pk_fma_f32 v[74:75], v[218:219], v[56:57], v[138:139] op_sel:[1,0,0] op_sel_hi:[1,1,1]
    v_pk_mul_f32 v[148:149], v[220:221], v[58:59] op_sel_hi:[0,1]
    v_pk_mul_f32 v[150:151], v[220:221], v[74:75] op_sel_hi:[0,1] neg_lo:[1,0] neg_hi:[1,0]
    ds_read_b128 a[168:171], v249 offset:0
    v_xor_b32 v249, 4096, v249
    v_pk_fma_f32 v[148:149], v[220:221], v[74:75], v[148:149] op_sel:[1,0,0] op_sel_hi:[1,1,1] neg_lo:[1,0,0] neg_hi:[1,0,0]
    v_pk_fma_f32 v[150:151], v[220:221], v[58:59], v[150:151] op_sel:[1,0,0] op_sel_hi:[1,1,1] neg_lo:[1,0,0] neg_hi:[1,0,0]
    v_cvt_pk_bf16_f32 v86, v144, v148
    v_cvt_pk_bf16_f32 v94, v145, v149
    v_cvt_pk_bf16_f32 v102, v146, v150
    ds_read_b128 a[176:179], v250 offset:0
    v_xor_b32 v250, 4096, v250
    v_cvt_pk_bf16_f32 v110, v147, v151
    buffer_store_dwordx4 v[88:91], v134, s[16:19], s73 offen offset:1024 sc1
    v_pk_fma_f32 v[136:137], v[218:219], v[58:59], v[60:61] op_sel_hi:[0,1,1]
    v_pk_fma_f32 v[138:139], v[218:219], v[74:75], v[76:77] op_sel_hi:[0,1,1]
    v_pk_fma_f32 v[60:61], v[218:219], v[74:75], v[136:137] op_sel:[1,0,0] op_sel_hi:[1,1,1] neg_lo:[1,0,0] neg_hi:[1,0,0]
    ds_read_b128 a[184:187], v251 offset:0
    v_xor_b32 v251, 4096, v251
    v_pk_fma_f32 v[76:77], v[218:219], v[58:59], v[138:139] op_sel:[1,0,0] op_sel_hi:[1,1,1]
    v_pk_mul_f32 v[152:153], v[220:221], v[60:61] op_sel_hi:[0,1]
    v_pk_mul_f32 v[154:155], v[220:221], v[76:77] op_sel_hi:[0,1] neg_lo:[1,0] neg_hi:[1,0]
    v_pk_fma_f32 v[152:153], v[220:221], v[76:77], v[152:153] op_sel:[1,0,0] op_sel_hi:[1,1,1] neg_lo:[1,0,0] neg_hi:[1,0,0]
    ds_read_b128 a[164:167], v248 offset:0
    v_pk_fma_f32 v[154:155], v[220:221], v[60:61], v[154:155] op_sel:[1,0,0] op_sel_hi:[1,1,1] neg_lo:[1,0,0] neg_hi:[1,0,0]
    v_pk_fma_f32 v[136:137], v[218:219], v[60:61], v[62:63] op_sel_hi:[0,1,1]
    v_pk_fma_f32 v[138:139], v[218:219], v[76:77], v[78:79] op_sel_hi:[0,1,1]
    v_pk_fma_f32 v[62:63], v[218:219], v[76:77], v[136:137] op_sel:[1,0,0] op_sel_hi:[1,1,1] neg_lo:[1,0,0] neg_hi:[1,0,0]
    v_pk_fma_f32 v[78:79], v[218:219], v[60:61], v[138:139] op_sel:[1,0,0] op_sel_hi:[1,1,1]
    ds_read_b128 a[172:175], v249 offset:0
    v_pk_mul_f32 v[156:157], v[220:221], v[62:63] op_sel_hi:[0,1]
    v_pk_mul_f32 v[158:159], v[220:221], v[78:79] op_sel_hi:[0,1] neg_lo:[1,0] neg_hi:[1,0]
    v_pk_fma_f32 v[156:157], v[220:221], v[78:79], v[156:157] op_sel:[1,0,0] op_sel_hi:[1,1,1] neg_lo:[1,0,0] neg_hi:[1,0,0]
    v_pk_fma_f32 v[158:159], v[220:221], v[62:63], v[158:159] op_sel:[1,0,0] op_sel_hi:[1,1,1] neg_lo:[1,0,0] neg_hi:[1,0,0]
    v_cvt_pk_bf16_f32 v87, v152, v156
    ds_read_b128 a[180:183], v250 offset:0
    v_cvt_pk_bf16_f32 v95, v153, v157
    v_cvt_pk_bf16_f32 v103, v154, v158
    v_cvt_pk_bf16_f32 v111, v155, v159
    buffer_store_dwordx4 v[104:107], v134, s[16:19], s74 offen offset:1024 sc1
    ds_read_b128 a[188:191], v251 offset:0
    v_add_u32 v248, s91, v244
    v_add_u32 v249, s91, v245
    v_add_u32 v250, s91, v246
    v_add_u32 v251, s91, v247
    s_waitcnt vmcnt(14) lgkmcnt(7)
    ds_read_b128 a[192:195], v248 offset:0
    v_xor_b32 v248, 4096, v248
    ds_read_b128 a[200:203], v249 offset:0
    v_xor_b32 v249, 4096, v249
    ds_read_b128 a[208:211], v250 offset:0
    v_xor_b32 v250, 4096, v250
    ds_read_b128 a[216:219], v251 offset:0
    v_xor_b32 v251, 4096, v251
    buffer_store_dwordx4 v[84:87], v133, s[16:19], s73 offen offset:512 sc1
    ds_read_b128 a[196:199], v248 offset:0
    ds_read_b128 a[204:207], v249 offset:0
    ds_read_b128 a[212:215], v250 offset:0
    ds_read_b128 a[220:223], v251 offset:0
    buffer_store_dwordx4 v[100:103], v133, s[16:19], s74 offen offset:512 sc1
    v_add_u32 v248, s92, v244
    v_add_u32 v249, s92, v245
    v_add_u32 v250, s92, v246
    v_add_u32 v251, s92, v247
    s_waitcnt vmcnt(7) lgkmcnt(7)
    ds_read_b128 a[224:227], v248 offset:0
    v_xor_b32 v248, 4096, v248
    ds_read_b128 a[232:235], v249 offset:0
    v_xor_b32 v249, 4096, v249
    ds_read_b128 a[240:243], v250 offset:0
    v_xor_b32 v250, 4096, v250
    ds_read_b128 a[248:251], v251 offset:0
    v_xor_b32 v251, 4096, v251
    buffer_store_dwordx4 v[92:95], v135, s[16:19], s73 offen offset:1536 sc1
    ds_read_b128 a[228:231], v248 offset:0
    ds_read_b128 a[236:239], v249 offset:0
    ds_read_b128 a[244:247], v250 offset:0
    ds_read_b128 a[252:255], v251 offset:0
    buffer_store_dwordx4 v[108:111], v135, s[16:19], s74 offen offset:1536 sc1
    s_lshl_b32 s101, s97, 7
    s_add_u32 s101, s101, 14745600
    s_branch .LG_3
    s_nop 15
.LZ_4:
    v_lshlrev_b32 v2, 4, v1
    v_mov_b32 v3, 2147483648
    s_and_b32 s81, s2, 1
    s_lshl_b32 s62, s81, 2
    s_bfe_u32 s63, s2, 0x20003
    s_add_u32 s58, s62, s63
    s_mov_b32 s11, 0x20000
    s_mul_i32 s82, s58, 12
    s_sub_u32 s82, s82, 2
    s_cmp_eq_u32 s58, 0
    s_cselect_b32 s82, 0, s82
    s_cselect_b32 s83, 10, 12
    s_cmp_eq_u32 s58, 7
    s_cselect_b32 s83, 4, s83
    v_add_u32 v112, 0, v1
    v_mul_u32_u24 v113, 171, v112
    v_lshrrev_b32 v113, 11, v113
    v_mul_u32_u24 v114, 12, v113
    v_sub_u32 v112, v112, v114
    v_cmp_le_u32 vcc, s83, v112
    v_mul_u32_u24 v113, 2752, v113
    v_lshl_add_u32 v112, v112, 4, v113
    v_add_u32 v112, 1376, v112
    v_cndmask_b32 v108, v112, v3, vcc
    v_add_u32 v112, 64, v1
    v_mul_u32_u24 v113, 171, v112
    v_lshrrev_b32 v113, 11, v113
    v_mul_u32_u24 v114, 12, v113
    v_sub_u32 v112, v112, v114
    v_cmp_le_u32 vcc, s83, v112
    v_mul_u32_u24 v113, 2752, v113
    v_lshl_add_u32 v112, v112, 4, v113
    v_add_u32 v112, 352, v112
    v_cndmask_b32 v109, v112, v3, vcc
    v_add_u32 v112, 128, v1
    v_mul_u32_u24 v113, 171, v112
    v_lshrrev_b32 v113, 11, v113
    v_mul_u32_u24 v114, 12, v113
    v_sub_u32 v112, v112, v114
    v_cmp_le_u32 vcc, s83, v112
    v_mul_u32_u24 v113, 2752, v113
    v_lshl_add_u32 v112, v112, 4, v113
    v_add_u32 v112, -672, v112
    v_cndmask_b32 v110, v112, v3, vcc
    s_mul_i32 s74, s56, 44032
    s_lshl_b32 s60, s82, 4
    s_add_u32 s74, s74, s60
    s_mul_i32 s76, s56, 3072
    s_add_u32 s76, s76, 16384
    s_mov_b32 s10, 1409024
    s_mov_b64 s[8:9], s[52:53]
    s_add_u32 m0, s76, 0
    s_add_u32 s68, s79, 0
    s_and_b32 s68, s68, 7
    s_mul_i32 s68, s68, 176128
    s_add_u32 s68, s68, s74
    buffer_load_dwordx4 v108, s[8:11], s68 offen offset:0 lds
    buffer_load_dwordx4 v109, s[8:11], s68 offen offset:1024 lds
    buffer_load_dwordx4 v110, s[8:11], s68 offen offset:2048 lds
    s_load_dwordx2 s[16:17], s[0:1], 136
    s_load_dwordx2 s[46:47], s[0:1], 112
    s_load_dwordx4 s[36:39], s[0:1], 8
    s_load_dwordx2 s[40:41], s[0:1], 56
    s_load_dwordx2 s[12:13], s[0:1], 88
    s_load_dwordx2 s[20:21], s[0:1], 40
    s_load_dwordx2 s[24:25], s[0:1], 48
    s_load_dwordx2 s[28:29], s[0:1], 104
    s_load_dwordx2 s[32:33], s[0:1], 120
    s_load_dwordx2 s[42:43], s[0:1], 64
    s_load_dwordx2 s[44:45], s[0:1], 96
    s_mov_b32 s14, 8388608
    s_mov_b32 s15, 0x20000
    s_add_u32 m0, s76, 40960
    s_add_u32 s68, s79, 1
    s_and_b32 s68, s68, 7
    s_mul_i32 s68, s68, 176128
    s_add_u32 s68, s68, s74
    s_mov_b32 s18, 20971520
    s_mov_b32 s19, 0x20000
    s_mov_b32 s22, 524288
    s_mov_b32 s23, 0x20000
    s_mov_b32 s26, 524288
    s_mov_b32 s27, 0x20000
    s_mov_b32 s30, 704512
    s_mov_b32 s31, 0x20000
    s_mov_b32 s34, 4194304
    s_mov_b32 s35, 0x20000
    s_and_b32 s62, s2, 6
    s_lshl_b32 s62, s62, 1
    s_lshr_b32 s59, s2, 6
    buffer_load_dwordx4 v108, s[8:11], s68 offen offset:0 lds
    s_add_u32 s59, s59, s62
    s_lshl_b32 s59, s59, 1
    s_add_u32 s59, s59, s81
    s_bfe_u32 s3, s2, 0x30003
    v_and_b32 v112, 31, v1
    v_lshlrev_b32 v112, 7, v112
    v_add_u32 v112, s96, v112
    v_bfe_u32 v113, v1, 1, 3
    v_lshrrev_b32 v96, 5, v1
    v_xor_b32 v113, v113, v96
    v_lshlrev_b32 v113, 4, v113
    v_xor_b32 v96, 0, v113
    v_add_u32 v96, v96, v112
    buffer_load_dwordx4 v109, s[8:11], s68 offen offset:1024 lds
    v_xor_b32 v97, 32, v113
    v_add_u32 v97, v97, v112
    v_xor_b32 v98, 64, v113
    v_add_u32 v98, v98, v112
    v_xor_b32 v99, 96, v113
    v_add_u32 v99, v99, v112
    v_lshrrev_b32 v112, 5, v1
    v_bfe_u32 v113, v1, 2, 2
    v_lshl_add_u32 v112, v112, 3, v113
    v_mul_u32_u24 v112, 192, v112
    v_bfe_u32 v113, v1, 4, 1
    v_lshl_add_u32 v112, v113, 5, v112
    v_and_b32 v113, 1, v1
    buffer_load_dwordx4 v110, s[8:11], s68 offen offset:2048 lds
    s_add_u32 m0, s96, 4096
    s_add_u32 s68, s79, 1
    s_and_b32 s68, s68, 7
    s_mul_i32 s68, s68, 128
    s_add_u32 s68, s68, s73
    v_lshl_add_u32 v112, v113, 4, v112
    v_bfe_u32 v113, v1, 1, 1
    v_lshl_add_u32 v112, v113, 3, v112
    v_add_u32 v100, 16384, v112
    v_add_u32 v101, 81920, v100
    v_lshrrev_b32 v112, 3, v1
    v_mul_u32_u24 v112, 4096, v112
    v_and_b32 v113, 7, v1
    v_lshrrev_b32 v240, 4, v1
    v_xor_b32 v113, v113, v240
    v_lshlrev_b32 v113, 4, v113
    v_add_u32 v240, v113, v112
    v_xor_b32 v113, 64, v113
    buffer_load_dwordx4 v104, s[4:7], s68 offen offset:0 lds
    v_add_u32 v241, v113, v112
    v_add_u32 v242, 63488, v240
    v_add_u32 v243, 95232, v241
    v_add_u32 v241, 31744, v241
    s_lshl_b32 s60, s81, 12
    v_and_b32 v112, 31, v1
    v_lshlrev_b32 v112, 7, v112
    v_add_u32 v112, s60, v112
    v_bfe_u32 v113, v1, 1, 3
    v_lshrrev_b32 v244, 5, v1
    v_xor_b32 v113, v113, v244
    v_lshlrev_b32 v113, 4, v113
    v_xor_b32 v244, 0, v113
    buffer_load_dwordx4 v105, s[4:7], s68 offen offset:1024 lds
    v_add_u32 v244, v244, v112
    v_xor_b32 v245, 32, v113
    v_add_u32 v245, v245, v112
    v_xor_b32 v246, 64, v113
    v_add_u32 v246, v246, v112
    v_xor_b32 v247, 96, v113
    v_add_u32 v247, v247, v112
    s_lshr_b32 s69, s59, 1
    s_lshl_b32 s69, s69, 19
    s_and_b32 s61, s56, 1
    s_lshl_b32 s61, s61, 18
    s_add_u32 s69, s69, s61
    s_lshl_b32 s61, s81, 11
    buffer_load_dwordx4 v106, s[4:7], s68 offen offset:2048 lds
    s_add_u32 s69, s69, s61
    s_lshr_b32 s61, s56, 1
    s_lshl_b32 s61, s61, 10
    s_add_u32 s69, s69, s61
    s_add_u32 s90, s96, 32768
    s_mov_b32 s91, s96
    s_add_u32 s92, s96, 8192
    s_add_u32 s93, s96, 16384
    s_add_u32 s94, s96, 24576
    s_mov_b32 s86, 1009429163
    s_mov_b32 s84, 0
    s_cmp_eq_u32 s58, 0
    s_cselect_b32 s86, 1011666125, s86
    s_cselect_b32 s84, 1098907648, s84
    s_cmp_eq_u32 s58, 7
    s_cselect_b32 s86, 1023410176, s86
    s_cselect_b32 s84, 1115684864, s84
    s_mov_b32 s80, 3184710632
    v_mov_b32 v252, 3222493025
    buffer_load_dwordx4 v107, s[4:7], s68 offen offset:3072 lds
    s_waitcnt lgkmcnt(0)
    s_cmp_lg_u32 s56, 0
    s_cbranch_scc1 .Lc2_11
    s_getpc_b64 s[64:65]
.Lpc_12:
    s_sub_u32 s64, s64, .Lpc_12-gated_mix__ssm_conv_s5__mixer_gmlp__prompt_kernel
    s_subb_u32 s65, s65, 0
    v_add_u32 v4, 32768, v4
    v_min_u32 v4, .Lend_1-gated_mix__ssm_conv_s5__mixer_gmlp__prompt_kernel, v4
    global_load_dword v5, v4, s[64:65]
.Lc2_11:
    s_load_dword s100, s[16:17], 0
    s_waitcnt lgkmcnt(0)
    s_mul_i32 s100, s100, 0x9E3779B1
    s_add_u32 s100, s100, 0x7F4A7C15
    s_waitcnt vmcnt(7)
    s_barrier
    ds_read_b128 v[88:91], v96 offset:0
    ds_read_b64_tr_b16 v[64:65], v100 offset:0
    ds_read_b64_tr_b16 v[66:67], v100 offset:768
    ds_read_b64_tr_b16 v[68:69], v100 offset:64
    ds_read_b64_tr_b16 v[70:71], v100 offset:832
    ds_read_b64_tr_b16 v[72:73], v100 offset:128
    ds_read_b64_tr_b16 v[74:75], v100 offset:896
    s_waitcnt lgkmcnt(4)
    v_mfma_f32_32x32x16_bf16 v[16:31], v[64:67], v[88:91], 0
    ds_read_b128 v[92:95], v97 offset:0
    ds_read_b64_tr_b16 v[76:77], v100 offset:3072
    ds_read_b64_tr_b16 v[78:79], v100 offset:3840
    s_waitcnt lgkmcnt(5)
    v_mfma_f32_32x32x16_bf16 v[32:47], v[68:71], v[88:91], 0
    ds_read_b64_tr_b16 v[80:81], v100 offset:3136
    s_add_u32 m0, s76, 81920
    s_add_u32 s68, s79, 2
    s_and_b32 s68, s68, 7
    s_mul_i32 s68, s68, 176128
    s_add_u32 s68, s68, s74
    ds_read_b64_tr_b16 v[82:83], v100 offset:3904
    buffer_load_dwordx4 v108, s[8:11], s68 offen offset:0 lds
    ds_read_b64_tr_b16 v[84:85], v100 offset:3200
    buffer_load_dwordx4 v109, s[8:11], s68 offen offset:1024 lds
    ds_read_b64_tr_b16 v[86:87], v100 offset:3968
    buffer_load_dwordx4 v110, s[8:11], s68 offen offset:2048 lds
    s_add_u32 m0, s96, 8192
    s_add_u32 s68, s79, 2
    s_and_b32 s68, s68, 7
    s_mul_i32 s68, s68, 128
    s_add_u32 s68, s68, s73
    s_waitcnt lgkmcnt(7)
    v_mfma_f32_32x32x16_bf16 v[48:63], v[72:75], v[88:91], 0
    buffer_load_dwordx4 v104, s[4:7], s68 offen offset:0 lds
    buffer_load_dwordx4 v105, s[4:7], s68 offen offset:1024 lds
    s_waitcnt lgkmcnt(4)
    v_mfma_f32_32x32x16_bf16 v[16:31], v[76:79], v[92:95], v[16:31]
    ds_read_b128 v[88:91], v98 offset:0
    ds_read_b64_tr_b16 v[64:65], v100 offset:6144
    ds_read_b64_tr_b16 v[66:67], v100 offset:6912
    s_waitcnt lgkmcnt(5)
    v_mfma_f32_32x32x16_bf16 v[32:47], v[80:83], v[92:95], v[32:47]
    ds_read_b64_tr_b16 v[68:69], v100 offset:6208
    buffer_load_dwordx4 v106, s[4:7], s68 offen offset:2048 lds
    ds_read_b64_tr_b16 v[70:71], v100 offset:6976
    buffer_load_dwordx4 v107, s[4:7], s68 offen offset:3072 lds
    ds_read_b64_tr_b16 v[72:73], v100 offset:6272
    s_add_u32 m0, s76, 122880
    s_add_u32 s68, s79, 3
    s_and_b32 s68, s68, 7
    s_mul_i32 s68, s68, 176128
    s_add_u32 s68, s68, s74
    ds_read_b64_tr_b16 v[74:75], v100 offset:7040
    buffer_load_dwordx4 v108, s[8:11], s68 offen offset:0 lds
    s_waitcnt lgkmcnt(7)
    v_mfma_f32_32x32x16_bf16 v[48:63], v[84:87], v[92:95], v[48:63]
    buffer_load_dwordx4 v109, s[8:11], s68 offen offset:1024 lds
    buffer_load_dwordx4 v110, s[8:11], s68 offen offset:2048 lds
    s_add_u32 m0, s96, 12288
    s_add_u32 s68, s79, 3
    s_and_b32 s68, s68, 7
    s_mul_i32 s68, s68, 128
    s_add_u32 s68, s68, s73
    s_waitcnt lgkmcnt(4)
    v_mfma_f32_32x32x16_bf16 v[16:31], v[64:67], v[88:91], v[16:31]
    ds_read_b128 v[92:95], v99 offset:0
    ds_read_b64_tr_b16 v[76:77], v100 offset:9216
    ds_read_b64_tr_b16 v[78:79], v100 offset:9984
    s_waitcnt lgkmcnt(5)
    v_mfma_f32_32x32x16_bf16 v[32:47], v[68:71], v[88:91], v[32:47]
    ds_read_b64_tr_b16 v[80:81], v100 offset:9280
    ds_read_b64_tr_b16 v[82:83], v100 offset:10048
    buffer_load_dwordx4 v104, s[4:7], s68 offen offset:0 lds
    ds_read_b64_tr_b16 v[84:85], v100 offset:9344
    buffer_load_dwordx4 v105, s[4:7], s68 offen offset:1024 lds
    ds_read_b64_tr_b16 v[86:87], v100 offset:10112
    buffer_load_dwordx4 v106, s[4:7], s68 offen offset:2048 lds
    s_waitcnt lgkmcnt(7)
    v_mfma_f32_32x32x16_bf16 v[48:63], v[72:75], v[88:91], v[48:63]
    buffer_load_dwordx4 v107, s[4:7], s68 offen offset:3072 lds
    s_waitcnt vmcnt(14) lgkmcnt(0)
    s_barrier
    v_mfma_f32_32x32x16_bf16 v[16:31], v[76:79], v[92:95], v[16:31]
    ds_read_b128 v[88:91], v96 offset:4096
    ds_read_b64_tr_b16 v[64:65], v100 offset:40960
    ds_read_b64_tr_b16 v[66:67], v100 offset:41728
    v_mfma_f32_32x32x16_bf16 v[32:47], v[80:83], v[92:95], v[32:47]
    ds_read_b64_tr_b16 v[68:69], v100 offset:41024
    ds_read_b64_tr_b16 v[70:71], v100 offset:41792
    ds_read_b64_tr_b16 v[72:73], v100 offset:41088
    s_add_u32 m0, s76, 0
    s_add_u32 s68, s79, 4
    s_and_b32 s68, s68, 7
    s_mul_i32 s68, s68, 176128
    s_add_u32 s68, s68, s74
    ds_read_b64_tr_b16 v[74:75], v100 offset:41856
    v_mfma_f32_32x32x16_bf16 v[48:63], v[84:87], v[92:95], v[48:63]
    buffer_load_dwordx4 v108, s[8:11], s68 offen offset:0 lds
    s_waitcnt lgkmcnt(4)
    v_mfma_f32_32x32x16_bf16 v[16:31], v[64:67], v[88:91], v[16:31]
    ds_read_b128 v[92:95], v97 offset:4096
    ds_read_b64_tr_b16 v[76:77], v100 offset:44032
    ds_read_b64_tr_b16 v[78:79], v100 offset:44800
    s_waitcnt lgkmcnt(5)
    v_mfma_f32_32x32x16_bf16 v[32:47], v[68:71], v[88:91], v[32:47]
    ds_read_b64_tr_b16 v[80:81], v100 offset:44096
    ds_read_b64_tr_b16 v[82:83], v100 offset:44864
    ds_read_b64_tr_b16 v[84:85], v100 offset:44160
    buffer_load_dwordx4 v109, s[8:11], s68 offen offset:1024 lds
    ds_read_b64_tr_b16 v[86:87], v100 offset:44928
    s_waitcnt lgkmcnt(7)
    v_mfma_f32_32x32x16_bf16 v[48:63], v[72:75], v[88:91], v[48:63]
    buffer_load_dwordx4 v110, s[8:11], s68 offen offset:2048 lds
    s_add_u32 m0, s96, 0
    s_add_u32 s68, s79, 4
    s_and_b32 s68, s68, 7
    s_mul_i32 s68, s68, 128
    s_add_u32 s68, s68, s73
    s_waitcnt lgkmcnt(4)
    v_mfma_f32_32x32x16_bf16 v[16:31], v[76:79], v[92:95], v[16:31]
    ds_read_b128 v[88:91], v98 offset:4096
    ds_read_b64_tr_b16 v[64:65], v100 offset:47104
    ds_read_b64_tr_b16 v[66:67], v100 offset:47872
    s_waitcnt lgkmcnt(5)
    v_mfma_f32_32x32x16_bf16 v[32:47], v[80:83], v[92:95], v[32:47]
    ds_read_b64_tr_b16 v[68:69], v100 offset:47168
    ds_read_b64_tr_b16 v[70:71], v100 offset:47936
    ds_read_b64_tr_b16 v[72:73], v100 offset:47232
    buffer_load_dwordx4 v104, s[4:7], s68 offen offset:0 lds
    ds_read_b64_tr_b16 v[74:75], v100 offset:48000
    s_waitcnt lgkmcnt(7)
    v_mfma_f32_32x32x16_bf16 v[48:63], v[84:87], v[92:95], v[48:63]
    buffer_load_dwordx4 v105, s[4:7], s68 offen offset:1024 lds
    s_waitcnt lgkmcnt(4)
    v_mfma_f32_32x32x16_bf16 v[16:31], v[64:67], v[88:91], v[16:31]
    ds_read_b128 v[92:95], v99 offset:4096
    ds_read_b64_tr_b16 v[76:77], v100 offset:50176
    ds_read_b64_tr_b16 v[78:79], v100 offset:50944
    s_waitcnt lgkmcnt(5)
    v_mfma_f32_32x32x16_bf16 v[32:47], v[68:71], v[88:91], v[32:47]
    ds_read_b64_tr_b16 v[80:81], v100 offset:50240
    ds_read_b64_tr_b16 v[82:83], v100 offset:51008
    ds_read_b64_tr_b16 v[84:85], v100 offset:50304
    buffer_load_dwordx4 v106, s[4:7], s68 offen offset:2048 lds
    ds_read_b64_tr_b16 v[86:87], v100 offset:51072
    s_waitcnt lgkmcnt(7)
    v_mfma_f32_32x32x16_bf16 v[48:63], v[72:75], v[88:91], v[48:63]
    buffer_load_dwordx4 v107, s[4:7], s68 offen offset:3072 lds
    s_waitcnt vmcnt(14) lgkmcnt(0)
    s_barrier
    v_mfma_f32_32x32x16_bf16 v[16:31], v[76:79], v[92:95], v[16:31]
    ds_read_b128 v[88:91], v96 offset:8192
    ds_read_b64_tr_b16 v[64:65], v101 offset:0
    ds_read_b64_tr_b16 v[66:67], v101 offset:768
    v_mfma_f32_32x32x16_bf16 v[32:47], v[80:83], v[92:95], v[32:47]
    ds_read_b64_tr_b16 v[68:69], v101 offset:64
    ds_read_b64_tr_b16 v[70:71], v101 offset:832
    ds_read_b64_tr_b16 v[72:73], v101 offset:128
    s_add_u32 m0, s76, 40960
    s_add_u32 s68, s79, 5
    s_and_b32 s68, s68, 7
    s_mul_i32 s68, s68, 176128
    s_add_u32 s68, s68, s74
    ds_read_b64_tr_b16 v[74:75], v101 offset:896
    v_mfma_f32_32x32x16_bf16 v[48:63], v[84:87], v[92:95], v[48:63]
    buffer_load_dwordx4 v108, s[8:11], s68 offen offset:0 lds
    s_waitcnt lgkmcnt(4)
    v_mfma_f32_32x32x16_bf16 v[16:31], v[64:67], v[88:91], v[16:31]
    ds_read_b128 v[92:95], v97 offset:8192
    ds_read_b64_tr_b16 v[76:77], v101 offset:3072
    ds_read_b64_tr_b16 v[78:79], v101 offset:3840
    s_waitcnt lgkmcnt(5)
    v_mfma_f32_32x32x16_bf16 v[32:47], v[68:71], v[88:91], v[32:47]
    ds_read_b64_tr_b16 v[80:81], v101 offset:3136
    ds_read_b64_tr_b16 v[82:83], v101 offset:3904
    ds_read_b64_tr_b16 v[84:85], v101 offset:3200
    buffer_load_dwordx4 v109, s[8:11], s68 offen offset:1024 lds
    ds_read_b64_tr_b16 v[86:87], v101 offset:3968
    s_waitcnt lgkmcnt(7)
    v_mfma_f32_32x32x16_bf16 v[48:63], v[72:75], v[88:91], v[48:63]
    buffer_load_dwordx4 v110, s[8:11], s68 offen offset:2048 lds
    s_add_u32 m0, s96, 4096
    s_add_u32 s68, s79, 5
    s_and_b32 s68, s68, 7
    s_mul_i32 s68, s68, 128
    s_add_u32 s68, s68, s73
    s_lshr_b32 s61, s2, 3
    s_lshl_b32 s61, s61, 2
    s_add_u32 s61, s61, s56
    s_and_b32 s60, s2, 7
    s_lshl_b32 s98, s61, 3
    s_add_u32 s98, s98, s60
    s_cmp_ge_u32 s98, 428
    s_cbranch_scc1 .Lzt_13
    s_cmp_lt_u32 s98, 128
    s_cselect_b64 s[64:65], s[20:21], s[24:25]
    s_and_b32 s60, s98, 127
    s_sub_u32 s61, s98, 256
    s_cmp_ge_u32 s98, 256
    s_cselect_b64 s[64:65], s[28:29], s[64:65]
    s_cselect_b32 s60, s61, s60
    s_lshl_b32 s60, s60, 12
    v_and_b32 v172, 31, v1
    v_lshl_add_u32 v172, v172, 7, s60
    global_load_dword v171, v172, s[64:65]
.Lzt_13:
    s_waitcnt lgkmcnt(4)
    v_mfma_f32_32x32x16_bf16 v[16:31], v[76:79], v[92:95], v[16:31]
    ds_read_b128 v[88:91], v98 offset:8192
    ds_read_b64_tr_b16 v[64:65], v101 offset:6144
    ds_read_b64_tr_b16 v[66:67], v101 offset:6912
    s_waitcnt lgkmcnt(5)
    v_mfma_f32_32x32x16_bf16 v[32:47], v[80:83], v[92:95], v[32:47]
    ds_read_b64_tr_b16 v[68:69], v101 offset:6208
    ds_read_b64_tr_b16 v[70:71], v101 offset:6976
    ds_read_b64_tr_b16 v[72:73], v101 offset:6272
    buffer_load_dwordx4 v104, s[4:7], s68 offen offset:0 lds
    ds_read_b64_tr_b16 v[74:75], v101 offset:7040
    s_waitcnt lgkmcnt(7)
    v_mfma_f32_32x32x16_bf16 v[48:63], v[84:87], v[92:95], v[48:63]
    buffer_load_dwordx4 v105, s[4:7], s68 offen offset:1024 lds
    s_waitcnt lgkmcnt(4)
    v_mfma_f32_32x32x16_bf16 v[16:31], v[64:67], v[88:91], v[16:31]
    ds_read_b128 v[92:95], v99 offset:8192
    ds_read_b64_tr_b16 v[76:77], v101 offset:9216
    ds_read_b64_tr_b16 v[78:79], v101 offset:9984
    s_waitcnt lgkmcnt(5)
    v_mfma_f32_32x32x16_bf16 v[32:47], v[68:71], v[88:91], v[32:47]
    ds_read_b64_tr_b16 v[80:81], v101 offset:9280
    ds_read_b64_tr_b16 v[82:83], v101 offset:10048
    ds_read_b64_tr_b16 v[84:85], v101 offset:9344
    buffer_load_dwordx4 v106, s[4:7], s68 offen offset:2048 lds
    ds_read_b64_tr_b16 v[86:87], v101 offset:10112
    s_waitcnt lgkmcnt(7)
    v_mfma_f32_32x32x16_bf16 v[48:63], v[72:75], v[88:91], v[48:63]
    buffer_load_dwordx4 v107, s[4:7], s68 offen offset:3072 lds
    s_waitcnt vmcnt(14) lgkmcnt(0)
    s_barrier
    v_mfma_f32_32x32x16_bf16 v[16:31], v[76:79], v[92:95], v[16:31]
    ds_read_b128 v[88:91], v96 offset:12288
    ds_read_b64_tr_b16 v[64:65], v101 offset:40960
    ds_read_b64_tr_b16 v[66:67], v101 offset:41728
    v_mfma_f32_32x32x16_bf16 v[32:47], v[80:83], v[92:95], v[32:47]
    ds_read_b64_tr_b16 v[68:69], v101 offset:41024
    ds_read_b64_tr_b16 v[70:71], v101 offset:41792
    ds_read_b64_tr_b16 v[72:73], v101 offset:41088
    s_add_u32 m0, s76, 81920
    s_add_u32 s68, s79, 6
    s_and_b32 s68, s68, 7
    s_mul_i32 s68, s68, 176128
    s_add_u32 s68, s68, s74
    ds_read_b64_tr_b16 v[74:75], v101 offset:41856
    v_mfma_f32_32x32x16_bf16 v[48:63], v[84:87], v[92:95], v[48:63]
    buffer_load_dwordx4 v108, s[8:11], s68 offen offset:0 lds
    s_waitcnt lgkmcnt(4)
    v_mfma_f32_32x32x16_bf16 v[16:31], v[64:67], v[88:91], v[16:31]
    ds_read_b128 v[92:95], v97 offset:12288
    ds_read_b64_tr_b16 v[76:77], v101 offset:44032
    ds_read_b64_tr_b16 v[78:79], v101 offset:44800
    s_waitcnt lgkmcnt(5)
    v_mfma_f32_32x32x16_bf16 v[32:47], v[68:71], v[88:91], v[32:47]
    ds_read_b64_tr_b16 v[80:81], v101 offset:44096
    ds_read_b64_tr_b16 v[82:83], v101 offset:44864
    ds_read_b64_tr_b16 v[84:85], v101 offset:44160
    buffer_load_dwordx4 v109, s[8:11], s68 offen offset:1024 lds
    ds_read_b64_tr_b16 v[86:87], v101 offset:44928
    s_waitcnt lgkmcnt(7)
    v_mfma_f32_32x32x16_bf16 v[48:63], v[72:75], v[88:91], v[48:63]
    buffer_load_dwordx4 v110, s[8:11], s68 offen offset:2048 lds
    s_add_u32 m0, s96, 8192
    s_add_u32 s68, s79, 6
    s_and_b32 s68, s68, 7
    s_mul_i32 s68, s68, 128
    s_add_u32 s68, s68, s73
    s_waitcnt lgkmcnt(4)
    v_mfma_f32_32x32x16_bf16 v[16:31], v[76:79], v[92:95], v[16:31]
    ds_read_b128 v[88:91], v98 offset:12288
    ds_read_b64_tr_b16 v[64:65], v101 offset:47104
    ds_read_b64_tr_b16 v[66:67], v101 offset:47872
    s_waitcnt lgkmcnt(5)
    v_mfma_f32_32x32x16_bf16 v[32:47], v[80:83], v[92:95], v[32:47]
    ds_read_b64_tr_b16 v[68:69], v101 offset:47168
    ds_read_b64_tr_b16 v[70:71], v101 offset:47936
    ds_read_b64_tr_b16 v[72:73], v101 offset:47232
    buffer_load_dwordx4 v104, s[4:7], s68 offen offset:0 lds
    ds_read_b64_tr_b16 v[74:75], v101 offset:48000
    s_waitcnt lgkmcnt(7)
    v_mfma_f32_32x32x16_bf16 v[48:63], v[84:87], v[92:95], v[48:63]
    buffer_load_dwordx4 v105, s[4:7], s68 offen offset:1024 lds
    s_lshl_b32 s97, s57, 2
    s_add_u32 s97, s97, s56
    s_lshl_b32 s97, s97, 3
    s_add_u32 s97, s97, s58
    s_lshl_b32 s60, s97, 12
    buffer_load_dwordx4 v[128:131], v2, s[4:7], s60 offen offset:0
    buffer_load_dwordx4 v[132:135], v2, s[4:7], s60 offen offset:1024
    buffer_load_dwordx4 v[136:139], v2, s[4:7], s60 offen offset:2048
    buffer_load_dwordx4 v[140:143], v2, s[4:7], s60 offen offset:3072
    global_load_dwordx4 v[144:147], v2, s[46:47]
    s_waitcnt lgkmcnt(4)
    v_mfma_f32_32x32x16_bf16 v[16:31], v[64:67], v[88:91], v[16:31]
    ds_read_b128 v[92:95], v99 offset:12288
    ds_read_b64_tr_b16 v[76:77], v101 offset:50176
    ds_read_b64_tr_b16 v[78:79], v101 offset:50944
    s_waitcnt lgkmcnt(5)
    v_mfma_f32_32x32x16_bf16 v[32:47], v[68:71], v[88:91], v[32:47]
    ds_read_b64_tr_b16 v[80:81], v101 offset:50240
    ds_read_b64_tr_b16 v[82:83], v101 offset:51008
    ds_read_b64_tr_b16 v[84:85], v101 offset:50304
    buffer_load_dwordx4 v106, s[4:7], s68 offen offset:2048 lds
    ds_read_b64_tr_b16 v[86:87], v101 offset:51072
    s_waitcnt lgkmcnt(7)
    v_mfma_f32_32x32x16_bf16 v[48:63], v[72:75], v[88:91], v[48:63]
    buffer_load_dwordx4 v107, s[4:7], s68 offen offset:3072 lds
    s_waitcnt vmcnt(19) lgkmcnt(0)
    s_barrier
    v_mfma_f32_32x32x16_bf16 v[16:31], v[76:79], v[92:95], v[16:31]
    ds_read_b128 v[88:91], v96 offset:0
    ds_read_b64_tr_b16 v[64:65], v100 offset:0
    ds_read_b64_tr_b16 v[66:67], v100 offset:768
    v_mfma_f32_32x32x16_bf16 v[32:47], v[80:83], v[92:95], v[32:47]
    ds_read_b64_tr_b16 v[68:69], v100 offset:64
    ds_read_b64_tr_b16 v[70:71], v100 offset:832
    ds_read_b64_tr_b16 v[72:73], v100 offset:128
    s_add_u32 m0, s76, 122880
    s_add_u32 s68, s79, 7
    s_and_b32 s68, s68, 7
    s_mul_i32 s68, s68, 176128
    s_add_u32 s68, s68, s74
    ds_read_b64_tr_b16 v[74:75], v100 offset:896
    v_mfma_f32_32x32x16_bf16 v[48:63], v[84:87], v[92:95], v[48:63]
    buffer_load_dwordx4 v108, s[8:11], s68 offen offset:0 lds
    s_waitcnt lgkmcnt(4)
    v_mfma_f32_32x32x16_bf16 v[16:31], v[64:67], v[88:91], v[16:31]
    ds_read_b128 v[92:95], v97 offset:0
    ds_read_b64_tr_b16 v[76:77], v100 offset:3072
    ds_read_b64_tr_b16 v[78:79], v100 offset:3840
    s_waitcnt lgkmcnt(5)
    v_mfma_f32_32x32x16_bf16 v[32:47], v[68:71], v[88:91], v[32:47]
    ds_read_b64_tr_b16 v[80:81], v100 offset:3136
    ds_read_b64_tr_b16 v[82:83], v100 offset:3904
    ds_read_b64_tr_b16 v[84:85], v100 offset:3200
    buffer_load_dwordx4 v109, s[8:11], s68 offen offset:1024 lds
    ds_read_b64_tr_b16 v[86:87], v100 offset:3968
    s_waitcnt lgkmcnt(7)
    v_mfma_f32_32x32x16_bf16 v[48:63], v[72:75], v[88:91], v[48:63]
    buffer_load_dwordx4 v110, s[8:11], s68 offen offset:2048 lds
    s_add_u32 m0, s96, 12288
    s_add_u32 s68, s79, 7
    s_and_b32 s68, s68, 7
    s_mul_i32 s68, s68, 128
    s_add_u32 s68, s68, s73
    s_waitcnt lgkmcnt(4)
    v_mfma_f32_32x32x16_bf16 v[16:31], v[76:79], v[92:95], v[16:31]
    ds_read_b128 v[88:91], v98 offset:0
    ds_read_b64_tr_b16 v[64:65], v100 offset:6144
    ds_read_b64_tr_b16 v[66:67], v100 offset:6912
    s_waitcnt lgkmcnt(5)
    v_mfma_f32_32x32x16_bf16 v[32:47], v[80:83], v[92:95], v[32:47]
    ds_read_b64_tr_b16 v[68:69], v100 offset:6208
    ds_read_b64_tr_b16 v[70:71], v100 offset:6976
    ds_read_b64_tr_b16 v[72:73], v100 offset:6272
    buffer_load_dwordx4 v104, s[4:7], s68 offen offset:0 lds
    ds_read_b64_tr_b16 v[74:75], v100 offset:7040
    s_waitcnt lgkmcnt(7)
    v_mfma_f32_32x32x16_bf16 v[48:63], v[84:87], v[92:95], v[48:63]
    buffer_load_dwordx4 v105, s[4:7], s68 offen offset:1024 lds
    s_waitcnt lgkmcnt(4)
    v_mfma_f32_32x32x16_bf16 v[16:31], v[64:67], v[88:91], v[16:31]
    ds_read_b128 v[92:95], v99 offset:0
    ds_read_b64_tr_b16 v[76:77], v100 offset:9216
    ds_read_b64_tr_b16 v[78:79], v100 offset:9984
    s_waitcnt lgkmcnt(5)
    v_mfma_f32_32x32x16_bf16 v[32:47], v[68:71], v[88:91], v[32:47]
    ds_read_b64_tr_b16 v[80:81], v100 offset:9280
    ds_read_b64_tr_b16 v[82:83], v100 offset:10048
    ds_read_b64_tr_b16 v[84:85], v100 offset:9344
    buffer_load_dwordx4 v106, s[4:7], s68 offen offset:2048 lds
    ds_read_b64_tr_b16 v[86:87], v100 offset:10112
    s_waitcnt lgkmcnt(7)
    v_mfma_f32_32x32x16_bf16 v[48:63], v[72:75], v[88:91], v[48:63]
    buffer_load_dwordx4 v107, s[4:7], s68 offen offset:3072 lds
    s_waitcnt vmcnt(19) lgkmcnt(0)
    s_barrier
    v_mfma_f32_32x32x16_bf16 v[16:31], v[76:79], v[92:95], v[16:31]
    ds_read_b128 v[88:91], v96 offset:4096
    ds_read_b64_tr_b16 v[64:65], v100 offset:40960
    ds_read_b64_tr_b16 v[66:67], v100 offset:41728
    v_mfma_f32_32x32x16_bf16 v[32:47], v[80:83], v[92:95], v[32:47]
    ds_read_b64_tr_b16 v[68:69], v100 offset:41024
    ds_read_b64_tr_b16 v[70:71], v100 offset:41792
    ds_read_b64_tr_b16 v[72:73], v100 offset:41088
    ds_read_b64_tr_b16 v[74:75], v100 offset:41856
    v_mfma_f32_32x32x16_bf16 v[48:63], v[84:87], v[92:95], v[48:63]
    s_lshr_b32 s61, s2, 3
    s_lshl_b32 s61, s61, 2
    s_add_u32 s61, s61, s56
    s_and_b32 s60, s2, 7
    s_lshl_b32 s71, s61, 3
    s_add_u32 s71, s71, s60
    s_lshr_b32 s60, s60, 1
    s_lshl_b32 s60, s60, 21
    s_lshl_b32 s61, s61, 14
    s_add_u32 s70, s60, s61
    s_lshl_b32 s60, s81, 11
    s_add_u32 s70, s70, s60
    v_lshrrev_b32 v173, 4, v1
    v_lshlrev_b32 v173, 12, v173
    v_and_b32 v174, 15, v1
    v_lshl_add_u32 v173, v174, 7, v173
    v_lshlrev_b32 v174, 7, v1
    buffer_load_dword v175, v173, s[12:15], s70 offen
    s_waitcnt lgkmcnt(4)
    v_mfma_f32_32x32x16_bf16 v[16:31], v[64:67], v[88:91], v[16:31]
    ds_read_b128 v[92:95], v97 offset:4096
    ds_read_b64_tr_b16 v[76:77], v100 offset:44032
    ds_read_b64_tr_b16 v[78:79], v100 offset:44800
    s_waitcnt lgkmcnt(5)
    v_mfma_f32_32x32x16_bf16 v[32:47], v[68:71], v[88:91], v[32:47]
    ds_read_b64_tr_b16 v[80:81], v100 offset:44096
    ds_read_b64_tr_b16 v[82:83], v100 offset:44864
    ds_read_b64_tr_b16 v[84:85], v100 offset:44160
    ds_read_b64_tr_b16 v[86:87], v100 offset:44928
    s_waitcnt lgkmcnt(7)
    v_mfma_f32_32x32x16_bf16 v[48:63], v[72:75], v[88:91], v[48:63]
    s_add_u32 s70, s70, 1048576
    buffer_load_dword v175, v173, s[12:15], s70 offen
    s_waitcnt lgkmcnt(4)
    v_mfma_f32_32x32x16_bf16 v[16:31], v[76:79], v[92:95], v[16:31]
    ds_read_b128 v[88:91], v98 offset:4096
    ds_read_b64_tr_b16 v[64:65], v100 offset:47104
    ds_read_b64_tr_b16 v[66:67], v100 offset:47872
    s_waitcnt lgkmcnt(5)
    v_mfma_f32_32x32x16_bf16 v[32:47], v[80:83], v[92:95], v[32:47]
    ds_read_b64_tr_b16 v[68:69], v100 offset:47168
    ds_read_b64_tr_b16 v[70:71], v100 offset:47936
    ds_read_b64_tr_b16 v[72:73], v100 offset:47232
    ds_read_b64_tr_b16 v[74:75], v100 offset:48000
    s_waitcnt lgkmcnt(7)
    v_mfma_f32_32x32x16_bf16 v[48:63], v[84:87], v[92:95], v[48:63]
    s_waitcnt lgkmcnt(4)
    v_mfma_f32_32x32x16_bf16 v[16:31], v[64:67], v[88:91], v[16:31]
    ds_read_b128 v[92:95], v99 offset:4096
    ds_read_b64_tr_b16 v[76:77], v100 offset:50176
    ds_read_b64_tr_b16 v[78:79], v100 offset:50944
    s_waitcnt lgkmcnt(5)
    v_mfma_f32_32x32x16_bf16 v[32:47], v[68:71], v[88:91], v[32:47]
    ds_read_b64_tr_b16 v[80:81], v100 offset:50240
    ds_read_b64_tr_b16 v[82:83], v100 offset:51008
    ds_read_b64_tr_b16 v[84:85], v100 offset:50304
    ds_read_b64_tr_b16 v[86:87], v100 offset:51072
    s_waitcnt lgkmcnt(7)
    v_mfma_f32_32x32x16_bf16 v[48:63], v[72:75], v[88:91], v[48:63]
    s_waitcnt vmcnt(9) lgkmcnt(0)
    s_barrier
    v_mfma_f32_32x32x16_bf16 v[16:31], v[76:79], v[92:95], v[16:31]
    ds_read_b128 v[88:91], v96 offset:8192
    ds_read_b64_tr_b16 v[64:65], v101 offset:0
    ds_read_b64_tr_b16 v[66:67], v101 offset:768
    v_mfma_f32_32x32x16_bf16 v[32:47], v[80:83], v[92:95], v[32:47]
    ds_read_b64_tr_b16 v[68:69], v101 offset:64
    ds_read_b64_tr_b16 v[70:71], v101 offset:832
    ds_read_b64_tr_b16 v[72:73], v101 offset:128
    ds_read_b64_tr_b16 v[74:75], v101 offset:896
    v_mfma_f32_32x32x16_bf16 v[48:63], v[84:87], v[92:95], v[48:63]
    s_waitcnt lgkmcnt(4)
    v_mfma_f32_32x32x16_bf16 v[16:31], v[64:67], v[88:91], v[16:31]
    ds_read_b128 v[92:95], v97 offset:8192
    ds_read_b64_tr_b16 v[76:77], v101 offset:3072
    ds_read_b64_tr_b16 v[78:79], v101 offset:3840
    s_waitcnt lgkmcnt(5)
    v_mfma_f32_32x32x16_bf16 v[32:47], v[68:71], v[88:91], v[32:47]
    ds_read_b64_tr_b16 v[80:81], v101 offset:3136
    ds_read_b64_tr_b16 v[82:83], v101 offset:3904
    ds_read_b64_tr_b16 v[84:85], v101 offset:3200
    ds_read_b64_tr_b16 v[86:87], v101 offset:3968
    s_waitcnt lgkmcnt(7)
    v_mfma_f32_32x32x16_bf16 v[48:63], v[72:75], v[88:91], v[48:63]
    s_waitcnt lgkmcnt(4)
    v_mfma_f32_32x32x16_bf16 v[16:31], v[76:79], v[92:95], v[16:31]
    ds_read_b128 v[88:91], v98 offset:8192
    ds_read_b64_tr_b16 v[64:65], v101 offset:6144
    ds_read_b64_tr_b16 v[66:67], v101 offset:6912
    s_waitcnt lgkmcnt(5)
    v_mfma_f32_32x32x16_bf16 v[32:47], v[80:83], v[92:95], v[32:47]
    ds_read_b64_tr_b16 v[68:69], v101 offset:6208
    ds_read_b64_tr_b16 v[70:71], v101 offset:6976
    ds_read_b64_tr_b16 v[72:73], v101 offset:6272
    ds_read_b64_tr_b16 v[74:75], v101 offset:7040
    s_waitcnt lgkmcnt(7)
    v_mfma_f32_32x32x16_bf16 v[48:63], v[84:87], v[92:95], v[48:63]
    s_waitcnt lgkmcnt(4)
    v_mfma_f32_32x32x16_bf16 v[16:31], v[64:67], v[88:91], v[16:31]
    ds_read_b128 v[92:95], v99 offset:8192
    ds_read_b64_tr_b16 v[76:77], v101 offset:9216
    ds_read_b64_tr_b16 v[78:79], v101 offset:9984
    s_waitcnt lgkmcnt(5)
    v_mfma_f32_32x32x16_bf16 v[32:47], v[68:71], v[88:91], v[32:47]
    ds_read_b64_tr_b16 v[80:81], v101 offset:9280
    ds_read_b64_tr_b16 v[82:83], v101 offset:10048
    ds_read_b64_tr_b16 v[84:85], v101 offset:9344
    ds_read_b64_tr_b16 v[86:87], v101 offset:10112
    s_waitcnt lgkmcnt(7)
    v_mfma_f32_32x32x16_bf16 v[48:63], v[72:75], v[88:91], v[48:63]
    s_waitcnt vmcnt(2) lgkmcnt(0)
    s_barrier
    v_mfma_f32_32x32x16_bf16 v[16:31], v[76:79], v[92:95], v[16:31]
    ds_read_b128 v[88:91], v96 offset:12288
    ds_read_b64_tr_b16 v[64:65], v101 offset:40960
    ds_read_b64_tr_b16 v[66:67], v101 offset:41728
    v_mfma_f32_32x32x16_bf16 v[32:47], v[80:83], v[92:95], v[32:47]
    ds_read_b64_tr_b16 v[68:69], v101 offset:41024
    ds_read_b64_tr_b16 v[70:71], v101 offset:41792
    ds_read_b64_tr_b16 v[72:73], v101 offset:41088
    ds_read_b64_tr_b16 v[74:75], v101 offset:41856
    v_mfma_f32_32x32x16_bf16 v[48:63], v[84:87], v[92:95], v[48:63]
    s_waitcnt lgkmcnt(4)
    v_mfma_f32_32x32x16_bf16 v[16:31], v[64:67], v[88:91], v[16:31]
    ds_read_b128 v[92:95], v97 offset:12288
    ds_read_b64_tr_b16 v[76:77], v101 offset:44032
    ds_read_b64_tr_b16 v[78:79], v101 offset:44800
    s_waitcnt lgkmcnt(5)
    v_mfma_f32_32x32x16_bf16 v[32:47], v[68:71], v[88:91], v[32:47]
    ds_read_b64_tr_b16 v[80:81], v101 offset:44096
    ds_read_b64_tr_b16 v[82:83], v101 offset:44864
    ds_read_b64_tr_b16 v[84:85], v101 offset:44160
    ds_read_b64_tr_b16 v[86:87], v101 offset:44928
    s_waitcnt lgkmcnt(7)
    v_mfma_f32_32x32x16_bf16 v[48:63], v[72:75], v[88:91], v[48:63]
    s_waitcnt lgkmcnt(4)
    v_mfma_f32_32x32x16_bf16 v[16:31], v[76:79], v[92:95], v[16:31]
    ds_read_b128 v[88:91], v98 offset:12288
    ds_read_b64_tr_b16 v[64:65], v101 offset:47104
    ds_read_b64_tr_b16 v[66:67], v101 offset:47872
    s_waitcnt lgkmcnt(5)
    v_mfma_f32_32x32x16_bf16 v[32:47], v[80:83], v[92:95], v[32:47]
    ds_read_b64_tr_b16 v[68:69], v101 offset:47168
    ds_read_b64_tr_b16 v[70:71], v101 offset:47936
    ds_read_b64_tr_b16 v[72:73], v101 offset:47232
    ds_read_b64_tr_b16 v[74:75], v101 offset:48000
    s_waitcnt lgkmcnt(7)
    v_mfma_f32_32x32x16_bf16 v[48:63], v[84:87], v[92:95], v[48:63]
    s_waitcnt lgkmcnt(4)
    v_mfma_f32_32x32x16_bf16 v[16:31], v[64:67], v[88:91], v[16:31]
    ds_read_b128 v[92:95], v99 offset:12288
    ds_read_b64_tr_b16 v[76:77], v101 offset:50176
    ds_read_b64_tr_b16 v[78:79], v101 offset:50944
    s_waitcnt lgkmcnt(5)
    v_mfma_f32_32x32x16_bf16 v[32:47], v[68:71], v[88:91], v[32:47]
    ds_read_b64_tr_b16 v[80:81], v101 offset:50240
    ds_read_b64_tr_b16 v[82:83], v101 offset:51008
    ds_read_b64_tr_b16 v[84:85], v101 offset:50304
    ds_read_b64_tr_b16 v[86:87], v101 offset:51072
    s_waitcnt lgkmcnt(7)
    v_mfma_f32_32x32x16_bf16 v[48:63], v[72:75], v[88:91], v[48:63]
    s_waitcnt lgkmcnt(4)
    v_mfma_f32_32x32x16_bf16 v[16:31], v[76:79], v[92:95], v[16:31]
    s_waitcnt lgkmcnt(2)
    v_mfma_f32_32x32x16_bf16 v[32:47], v[80:83], v[92:95], v[32:47]
    s_waitcnt lgkmcnt(0)
    v_mfma_f32_32x32x16_bf16 v[48:63], v[84:87], v[92:95], v[48:63]
    s_nop 7
    v_pk_mul_f32 v[64:65], v[16:17], v[16:17]
    v_pk_mul_f32 v[68:69], v[18:19], v[18:19]
    v_pk_mul_f32 v[72:73], v[20:21], v[20:21]
    v_pk_mul_f32 v[76:77], v[22:23], v[22:23]
    v_pk_fma_f32 v[64:65], v[64:65], s[80:81], v[252:253] op_sel_hi:[1,0,0]
    v_pk_fma_f32 v[68:69], v[68:69], s[80:81], v[252:253] op_sel_hi:[1,0,0]
    v_pk_fma_f32 v[72:73], v[72:73], s[80:81], v[252:253] op_sel_hi:[1,0,0]
    v_pk_fma_f32 v[76:77], v[76:77], s[80:81], v[252:253] op_sel_hi:[1,0,0]
    v_pk_mul_f32 v[64:65], v[64:65], v[16:17]
    v_pk_mul_f32 v[68:69], v[68:69], v[18:19]
    v_pk_mul_f32 v[72:73], v[72:73], v[20:21]
    v_pk_mul_f32 v[76:77], v[76:77], v[22:23]
    v_exp_f32 v64, v64
    v_exp_f32 v68, v68
    v_exp_f32 v72, v72
    v_exp_f32 v76, v76
    v_exp_f32 v65, v65
    v_exp_f32 v69, v69
    v_exp_f32 v73, v73
    v_exp_f32 v77, v77
    v_pk_add_f32 v[64:65], v[64:65], 1.0 op_sel_hi:[1,0]
    v_pk_add_f32 v[68:69], v[68:69], 1.0 op_sel_hi:[1,0]
    v_pk_add_f32 v[72:73], v[72:73], 1.0 op_sel_hi:[1,0]
    v_pk_add_f32 v[76:77], v[76:77], 1.0 op_sel_hi:[1,0]
    v_rcp_f32 v64, v64
    v_rcp_f32 v68, v68
    v_rcp_f32 v72, v72
    v_rcp_f32 v76, v76
    v_rcp_f32 v65, v65
    v_rcp_f32 v69, v69
    v_rcp_f32 v73, v73
    v_rcp_f32 v77, v77
    v_pk_mul_f32 v[16:17], v[64:65], v[16:17]
    v_pk_mul_f32 v[18:19], v[68:69], v[18:19]
    v_pk_mul_f32 v[20:21], v[72:73], v[20:21]
    v_pk_mul_f32 v[22:23], v[76:77], v[22:23]
    v_pk_mul_f32 v[64:65], v[24:25], v[24:25]
    v_pk_mul_f32 v[68:69], v[26:27], v[26:27]
    v_pk_mul_f32 v[72:73], v[28:29], v[28:29]
    v_pk_mul_f32 v[76:77], v[30:31], v[30:31]
    v_pk_fma_f32 v[64:65], v[64:65], s[80:81], v[252:253] op_sel_hi:[1,0,0]
    v_pk_fma_f32 v[68:69], v[68:69], s[80:81], v[252:253] op_sel_hi:[1,0,0]
    v_pk_fma_f32 v[72:73], v[72:73], s[80:81], v[252:253] op_sel_hi:[1,0,0]
    s_barrier
    v_pk_fma_f32 v[76:77], v[76:77], s[80:81], v[252:253] op_sel_hi:[1,0,0]
    v_pk_mul_f32 v[64:65], v[64:65], v[24:25]
    v_pk_mul_f32 v[68:69], v[68:69], v[26:27]
    v_pk_mul_f32 v[72:73], v[72:73], v[28:29]
    v_pk_mul_f32 v[76:77], v[76:77], v[30:31]
    v_exp_f32 v64, v64
    v_exp_f32 v68, v68
    v_exp_f32 v72, v72
    v_exp_f32 v76, v76
    v_exp_f32 v65, v65
    v_exp_f32 v69, v69
    v_exp_f32 v73, v73
    v_exp_f32 v77, v77
    v_pk_add_f32 v[64:65], v[64:65], 1.0 op_sel_hi:[1,0]
    v_pk_add_f32 v[68:69], v[68:69], 1.0 op_sel_hi:[1,0]
    v_pk_add_f32 v[72:73], v[72:73], 1.0 op_sel_hi:[1,0]
    v_pk_add_f32 v[76:77], v[76:77], 1.0 op_sel_hi:[1,0]
    v_rcp_f32 v64, v64
    v_rcp_f32 v68, v68
    v_rcp_f32 v72, v72
    v_rcp_f32 v76, v76
    v_rcp_f32 v65, v65
    v_rcp_f32 v69, v69
    v_rcp_f32 v73, v73
    v_rcp_f32 v77, v77
    v_pk_mul_f32 v[24:25], v[64:65], v[24:25]
    v_pk_mul_f32 v[26:27], v[68:69], v[26:27]
    v_pk_mul_f32 v[28:29], v[72:73], v[28:29]
    v_pk_mul_f32 v[30:31], v[76:77], v[30:31]
    v_pk_mul_f32 v[64:65], v[32:33], v[32:33]
    v_pk_mul_f32 v[68:69], v[34:35], v[34:35]
    v_pk_mul_f32 v[72:73], v[36:37], v[36:37]
    v_pk_mul_f32 v[76:77], v[38:39], v[38:39]
    v_pk_fma_f32 v[64:65], v[64:65], s[80:81], v[252:253] op_sel_hi:[1,0,0]
    v_pk_fma_f32 v[68:69], v[68:69], s[80:81], v[252:253] op_sel_hi:[1,0,0]
    v_pk_fma_f32 v[72:73], v[72:73], s[80:81], v[252:253] op_sel_hi:[1,0,0]
    v_pk_fma_f32 v[76:77], v[76:77], s[80:81], v[252:253] op_sel_hi:[1,0,0]
    v_pk_mul_f32 v[64:65], v[64:65], v[32:33]
    v_pk_mul_f32 v[68:69], v[68:69], v[34:35]
    v_pk_mul_f32 v[72:73], v[72:73], v[36:37]
    v_pk_mul_f32 v[76:77], v[76:77], v[38:39]
    v_exp_f32 v64, v64
    v_exp_f32 v68, v68
    v_exp_f32 v72, v72
    v_exp_f32 v76, v76
    v_exp_f32 v65, v65
    v_exp_f32 v69, v69
    v_exp_f32 v73, v73
    v_exp_f32 v77, v77
    v_pk_add_f32 v[64:65], v[64:65], 1.0 op_sel_hi:[1,0]
    v_pk_add_f32 v[68:69], v[68:69], 1.0 op_sel_hi:[1,0]
    v_pk_add_f32 v[72:73], v[72:73], 1.0 op_sel_hi:[1,0]
    v_pk_add_f32 v[76:77], v[76:77], 1.0 op_sel_hi:[1,0]
    v_rcp_f32 v64, v64
    v_rcp_f32 v68, v68
    v_rcp_f32 v72, v72
    v_rcp_f32 v76, v76
    v_rcp_f32 v65, v65
    v_rcp_f32 v69, v69
    v_rcp_f32 v73, v73
    v_rcp_f32 v77, v77
    v_pk_mul_f32 v[32:33], v[64:65], v[32:33]
    v_pk_mul_f32 v[34:35], v[68:69], v[34:35]
    v_pk_mul_f32 v[36:37], v[72:73], v[36:37]
    v_pk_mul_f32 v[38:39], v[76:77], v[38:39]
    v_pk_mul_f32 v[64:65], v[40:41], v[40:41]
    v_pk_mul_f32 v[68:69], v[42:43], v[42:43]
    v_pk_mul_f32 v[72:73], v[44:45], v[44:45]
    v_pk_mul_f32 v[76:77], v[46:47], v[46:47]
    v_pk_fma_f32 v[64:65], v[64:65], s[80:81], v[252:253] op_sel_hi:[1,0,0]
    v_pk_fma_f32 v[68:69], v[68:69], s[80:81], v[252:253] op_sel_hi:[1,0,0]
    v_pk_fma_f32 v[72:73], v[72:73], s[80:81], v[252:253] op_sel_hi:[1,0,0]
    v_pk_fma_f32 v[76:77], v[76:77], s[80:81], v[252:253] op_sel_hi:[1,0,0]
    v_pk_mul_f32 v[64:65], v[64:65], v[40:41]
    v_pk_mul_f32 v[68:69], v[68:69], v[42:43]
    v_pk_mul_f32 v[72:73], v[72:73], v[44:45]
    v_pk_mul_f32 v[76:77], v[76:77], v[46:47]
    v_exp_f32 v64, v64
    v_exp_f32 v68, v68
    v_exp_f32 v72, v72
    v_exp_f32 v76, v76
    v_exp_f32 v65, v65
    v_exp_f32 v69, v69
    v_exp_f32 v73, v73
    v_exp_f32 v77, v77
    v_pk_add_f32 v[64:65], v[64:65], 1.0 op_sel_hi:[1,0]
    v_pk_add_f32 v[68:69], v[68:69], 1.0 op_sel_hi:[1,0]
    v_pk_add_f32 v[72:73], v[72:73], 1.0 op_sel_hi:[1,0]
    v_pk_add_f32 v[76:77], v[76:77], 1.0 op_sel_hi:[1,0]
    v_rcp_f32 v64, v64
    v_rcp_f32 v68, v68
    v_rcp_f32 v72, v72
    v_rcp_f32 v76, v76
    v_rcp_f32 v65, v65
    v_rcp_f32 v69, v69
    v_rcp_f32 v73, v73
    v_rcp_f32 v77, v77
    v_pk_mul_f32 v[40:41], v[64:65], v[40:41]
    v_pk_mul_f32 v[42:43], v[68:69], v[42:43]
    v_pk_mul_f32 v[44:45], v[72:73], v[44:45]
    v_pk_mul_f32 v[46:47], v[76:77], v[46:47]
    v_pk_mul_f32 v[64:65], v[48:49], v[48:49]
    v_pk_mul_f32 v[68:69], v[50:51], v[50:51]
    v_pk_mul_f32 v[72:73], v[52:53], v[52:53]
    v_pk_mul_f32 v[76:77], v[54:55], v[54:55]
    v_pk_fma_f32 v[64:65], v[64:65], s[80:81], v[252:253] op_sel_hi:[1,0,0]
    v_pk_fma_f32 v[68:69], v[68:69], s[80:81], v[252:253] op_sel_hi:[1,0,0]
    v_pk_fma_f32 v[72:73], v[72:73], s[80:81], v[252:253] op_sel_hi:[1,0,0]
    v_pk_fma_f32 v[76:77], v[76:77], s[80:81], v[252:253] op_sel_hi:[1,0,0]
    v_pk_mul_f32 v[64:65], v[64:65], v[48:49]
    v_pk_mul_f32 v[68:69], v[68:69], v[50:51]
    v_pk_mul_f32 v[72:73], v[72:73], v[52:53]
    v_pk_mul_f32 v[76:77], v[76:77], v[54:55]
    v_exp_f32 v64, v64
    v_exp_f32 v68, v68
    v_exp_f32 v72, v72
    v_exp_f32 v76, v76
    v_exp_f32 v65, v65
    v_exp_f32 v69, v69
    v_exp_f32 v73, v73
    v_exp_f32 v77, v77
    v_pk_add_f32 v[64:65], v[64:65], 1.0 op_sel_hi:[1,0]
    v_pk_add_f32 v[68:69], v[68:69], 1.0 op_sel_hi:[1,0]
    v_pk_add_f32 v[72:73], v[72:73], 1.0 op_sel_hi:[1,0]
    v_pk_add_f32 v[76:77], v[76:77], 1.0 op_sel_hi:[1,0]
    v_rcp_f32 v64, v64
    v_rcp_f32 v68, v68
    v_rcp_f32 v72, v72
    v_rcp_f32 v76, v76
    v_rcp_f32 v65, v65
    v_rcp_f32 v69, v69
    v_rcp_f32 v73, v73
    v_rcp_f32 v77, v77
    v_pk_mul_f32 v[48:49], v[64:65], v[48:49]
    v_pk_mul_f32 v[50:51], v[68:69], v[50:51]
    v_pk_mul_f32 v[52:53], v[72:73], v[52:53]
    v_pk_mul_f32 v[54:55], v[76:77], v[54:55]
    v_pk_mul_f32 v[64:65], v[56:57], v[56:57]
    v_pk_mul_f32 v[68:69], v[58:59], v[58:59]
    v_pk_mul_f32 v[72:73], v[60:61], v[60:61]
    v_pk_mul_f32 v[76:77], v[62:63], v[62:63]
    v_pk_fma_f32 v[64:65], v[64:65], s[80:81], v[252:253] op_sel_hi:[1,0,0]
    v_pk_fma_f32 v[68:69], v[68:69], s[80:81], v[252:253] op_sel_hi:[1,0,0]
    v_pk_fma_f32 v[72:73], v[72:73], s[80:81], v[252:253] op_sel_hi:[1,0,0]
    v_pk_fma_f32 v[76:77], v[76:77], s[80:81], v[252:253] op_sel_hi:[1,0,0]
    v_pk_mul_f32 v[64:65], v[64:65], v[56:57]
    v_pk_mul_f32 v[68:69], v[68:69], v[58:59]
    v_pk_mul_f32 v[72:73], v[72:73], v[60:61]
    v_pk_mul_f32 v[76:77], v[76:77], v[62:63]
    v_exp_f32 v64, v64
    v_exp_f32 v68, v68
    v_exp_f32 v72, v72
    v_exp_f32 v76, v76
    v_exp_f32 v65, v65
    v_exp_f32 v69, v69
    v_exp_f32 v73, v73
    v_exp_f32 v77, v77
    v_pk_add_f32 v[64:65], v[64:65], 1.0 op_sel_hi:[1,0]
    v_pk_add_f32 v[68:69], v[68:69], 1.0 op_sel_hi:[1,0]
    v_pk_add_f32 v[72:73], v[72:73], 1.0 op_sel_hi:[1,0]
    v_pk_add_f32 v[76:77], v[76:77], 1.0 op_sel_hi:[1,0]
    v_rcp_f32 v64, v64
    v_rcp_f32 v68, v68
    v_rcp_f32 v72, v72
    v_rcp_f32 v76, v76
    v_rcp_f32 v65, v65
    v_rcp_f32 v69, v69
    v_rcp_f32 v73, v73
    v_rcp_f32 v77, v77
    v_pk_mul_f32 v[56:57], v[64:65], v[56:57]
    v_pk_mul_f32 v[58:59], v[68:69], v[58:59]
    v_pk_mul_f32 v[60:61], v[72:73], v[60:61]
    v_pk_mul_f32 v[62:63], v[76:77], v[62:63]
    v_pk_add_f32 v[64:65], v[16:17], v[24:25]
    v_pk_add_f32 v[66:67], v[18:19], v[26:27]
    v_pk_add_f32 v[68:69], v[20:21], v[28:29]
    v_pk_add_f32 v[70:71], v[22:23], v[30:31]
    v_pk_add_f32 v[64:65], v[64:65], v[32:33]
    v_pk_add_f32 v[66:67], v[66:67], v[34:35]
    v_pk_add_f32 v[68:69], v[68:69], v[36:37]
    v_pk_add_f32 v[70:71], v[70:71], v[38:39]
    v_pk_add_f32 v[64:65], v[64:65], v[40:41]
    v_pk_add_f32 v[66:67], v[66:67], v[42:43]
    v_pk_add_f32 v[68:69], v[68:69], v[44:45]
    v_pk_add_f32 v[70:71], v[70:71], v[46:47]
    v_pk_add_f32 v[64:65], v[64:65], v[48:49]
    v_pk_add_f32 v[66:67], v[66:67], v[50:51]
    v_pk_add_f32 v[68:69], v[68:69], v[52:53]
    v_pk_add_f32 v[70:71], v[70:71], v[54:55]
    v_pk_add_f32 v[64:65], v[64:65], v[56:57]
    v_pk_add_f32 v[66:67], v[66:67], v[58:59]
    v_pk_add_f32 v[68:69], v[68:69], v[60:61]
    v_pk_add_f32 v[70:71], v[70:71], v[62:63]
    v_pk_add_f32 v[64:65], v[64:65], v[66:67]
    v_pk_add_f32 v[68:69], v[68:69], v[70:71]
    v_mov_b32 v73, s100
    v_pk_add_f32 v[64:65], v[64:65], v[68:69]
    v_mov_b32 v75, s100
    v_add_f32 v72, v64, v65
    v_cmp_gt_u32 vcc, 32, v1
    v_mov_b32 v64, v72
    s_lshl_b32 s62, s57, 2
    s_add_u32 s62, s62, s56
    v_permlane32_swap_b32 v72, v64
    v_cndmask_b32 v80, v3, v2, vcc
    v_add_f32 v72, v72, v64
    s_lshl_b32 s63, s62, 12
    s_add_u32 s63, s63, 65536
    v_mul_f32 v126, s86, v72
    s_lshl_b32 s60, s58, 9
    s_add_u32 s60, s60, s63
    v_pk_add_f32 v[16:17], v[16:17], v[126:127] op_sel_hi:[1,0] neg_lo:[0,1] neg_hi:[0,1]
    v_pk_add_f32 v[18:19], v[18:19], v[126:127] op_sel_hi:[1,0] neg_lo:[0,1] neg_hi:[0,1]
    v_pk_add_f32 v[20:21], v[20:21], v[126:127] op_sel_hi:[1,0] neg_lo:[0,1] neg_hi:[0,1]
    v_pk_add_f32 v[22:23], v[22:23], v[126:127] op_sel_hi:[1,0] neg_lo:[0,1] neg_hi:[0,1]
    v_pk_add_f32 v[24:25], v[24:25], v[126:127] op_sel_hi:[1,0] neg_lo:[0,1] neg_hi:[0,1]
    v_pk_add_f32 v[26:27], v[26:27], v[126:127] op_sel_hi:[1,0] neg_lo:[0,1] neg_hi:[0,1]
    v_pk_add_f32 v[28:29], v[28:29], v[126:127] op_sel_hi:[1,0] neg_lo:[0,1] neg_hi:[0,1]
    v_pk_add_f32 v[30:31], v[30:31], v[126:127] op_sel_hi:[1,0] neg_lo:[0,1] neg_hi:[0,1]
    v_pk_add_f32 v[32:33], v[32:33], v[126:127] op_sel_hi:[1,0] neg_lo:[0,1] neg_hi:[0,1]
    v_pk_add_f32 v[34:35], v[34:35], v[126:127] op_sel_hi:[1,0] neg_lo:[0,1] neg_hi:[0,1]
    v_pk_add_f32 v[36:37], v[36:37], v[126:127] op_sel_hi:[1,0] neg_lo:[0,1] neg_hi:[0,1]
    v_pk_add_f32 v[38:39], v[38:39], v[126:127] op_sel_hi:[1,0] neg_lo:[0,1] neg_hi:[0,1]
    v_pk_add_f32 v[40:41], v[40:41], v[126:127] op_sel_hi:[1,0] neg_lo:[0,1] neg_hi:[0,1]
    v_pk_add_f32 v[42:43], v[42:43], v[126:127] op_sel_hi:[1,0] neg_lo:[0,1] neg_hi:[0,1]
    v_pk_add_f32 v[44:45], v[44:45], v[126:127] op_sel_hi:[1,0] neg_lo:[0,1] neg_hi:[0,1]
    v_pk_add_f32 v[46:47], v[46:47], v[126:127] op_sel_hi:[1,0] neg_lo:[0,1] neg_hi:[0,1]
    v_pk_add_f32 v[48:49], v[48:49], v[126:127] op_sel_hi:[1,0] neg_lo:[0,1] neg_hi:[0,1]
    v_pk_add_f32 v[50:51], v[50:51], v[126:127] op_sel_hi:[1,0] neg_lo:[0,1] neg_hi:[0,1]
    v_pk_add_f32 v[52:53], v[52:53], v[126:127] op_sel_hi:[1,0] neg_lo:[0,1] neg_hi:[0,1]
    v_pk_add_f32 v[54:55], v[54:55], v[126:127] op_sel_hi:[1,0] neg_lo:[0,1] neg_hi:[0,1]
    v_pk_add_f32 v[56:57], v[56:57], v[126:127] op_sel_hi:[1,0] neg_lo:[0,1] neg_hi:[0,1]
    v_pk_add_f32 v[58:59], v[58:59], v[126:127] op_sel_hi:[1,0] neg_lo:[0,1] neg_hi:[0,1]
    v_pk_add_f32 v[60:61], v[60:61], v[126:127] op_sel_hi:[1,0] neg_lo:[0,1] neg_hi:[0,1]
    v_pk_add_f32 v[62:63], v[62:63], v[126:127] op_sel_hi:[1,0] neg_lo:[0,1] neg_hi:[0,1]
    v_pk_mul_f32 v[64:65], v[16:17], v[16:17]
    v_pk_mul_f32 v[66:67], v[18:19], v[18:19]
    v_pk_mul_f32 v[68:69], v[20:21], v[20:21]
    v_pk_mul_f32 v[70:71], v[22:23], v[22:23]
    v_pk_fma_f32 v[64:65], v[24:25], v[24:25], v[64:65]
    v_pk_fma_f32 v[66:67], v[26:27], v[26:27], v[66:67]
    v_pk_fma_f32 v[68:69], v[28:29], v[28:29], v[68:69]
    v_pk_fma_f32 v[70:71], v[30:31], v[30:31], v[70:71]
    v_pk_fma_f32 v[64:65], v[32:33], v[32:33], v[64:65]
    v_pk_fma_f32 v[66:67], v[34:35], v[34:35], v[66:67]
    v_pk_fma_f32 v[68:69], v[36:37], v[36:37], v[68:69]
    v_pk_fma_f32 v[70:71], v[38:39], v[38:39], v[70:71]
    v_pk_fma_f32 v[64:65], v[40:41], v[40:41], v[64:65]
    v_pk_fma_f32 v[66:67], v[42:43], v[42:43], v[66:67]
    v_pk_fma_f32 v[68:69], v[44:45], v[44:45], v[68:69]
    v_pk_fma_f32 v[70:71], v[46:47], v[46:47], v[70:71]
    v_pk_fma_f32 v[64:65], v[48:49], v[48:49], v[64:65]
    v_pk_fma_f32 v[66:67], v[50:51], v[50:51], v[66:67]
    v_pk_fma_f32 v[68:69], v[52:53], v[52:53], v[68:69]
    v_pk_fma_f32 v[70:71], v[54:55], v[54:55], v[70:71]
    v_pk_fma_f32 v[64:65], v[56:57], v[56:57], v[64:65]
    v_pk_fma_f32 v[66:67], v[58:59], v[58:59], v[66:67]
    v_pk_fma_f32 v[68:69], v[60:61], v[60:61], v[68:69]
    v_pk_fma_f32 v[70:71], v[62:63], v[62:63], v[70:71]
    v_mul_f32 v76, s84, v126
    v_pk_add_f32 v[64:65], v[64:65], v[66:67]
    v_pk_add_f32 v[68:69], v[68:69], v[70:71]
    v_pk_add_f32 v[64:65], v[64:65], v[68:69]
    v_add_f32 v74, v64, v65
    v_mov_b32 v64, v74
    s_nop 1
    v_permlane32_swap_b32 v74, v64
    v_add_f32 v74, v74, v64
    v_fma_f32 v74, -v76, v126, v74
    buffer_store_dwordx4 v[72:75], v80, s[16:19], s60 offen sc1
    v_dot2_f32_bf16 v156, v128, v144, 0
    v_dot2_f32_bf16 v157, v132, v144, 0
    v_dot2_f32_bf16 v158, v136, v144, 0
    v_dot2_f32_bf16 v159, v140, v144, 0
    v_dot2_f32_bf16 v156, v129, v145, v156
    v_dot2_f32_bf16 v157, v133, v145, v157
    v_dot2_f32_bf16 v158, v137, v145, v158
    v_dot2_f32_bf16 v159, v141, v145, v159
    v_dot2_f32_bf16 v156, v130, v146, v156
    s_add_u32 m0, s90, 0
    s_add_u32 s68, s69, 0
    v_dot2_f32_bf16 v157, v134, v146, v157
    v_dot2_f32_bf16 v158, v138, v146, v158
    v_dot2_f32_bf16 v159, v142, v146, v159
    v_dot2_f32_bf16 v156, v131, v147, v156
    v_dot2_f32_bf16 v157, v135, v147, v157
    v_dot2_f32_bf16 v158, v139, v147, v158
    v_dot2_f32_bf16 v159, v143, v147, v159
    s_nop 2
    v_add_f32_dpp v156, v156, v156 quad_perm:[1,0,3,2] row_mask:0xf bank_mask:0xf
    v_add_f32_dpp v157, v157, v157 quad_perm:[1,0,3,2] row_mask:0xf bank_mask:0xf
    buffer_load_dwordx4 v240, s[12:15], s68 offen offset:0  lds
    v_add_f32_dpp v158, v158, v158 quad_perm:[1,0,3,2] row_mask:0xf bank_mask:0xf
    v_add_f32_dpp v159, v159, v159 quad_perm:[1,0,3,2] row_mask:0xf bank_mask:0xf
    v_add_f32_dpp v156, v156, v156 quad_perm:[2,3,0,1] row_mask:0xf bank_mask:0xf
    v_add_f32_dpp v157, v157, v157 quad_perm:[2,3,0,1] row_mask:0xf bank_mask:0xf
    v_add_f32_dpp v158, v158, v158 quad_perm:[2,3,0,1] row_mask:0xf bank_mask:0xf
    v_add_f32_dpp v159, v159, v159 quad_perm:[2,3,0,1] row_mask:0xf bank_mask:0xf
    v_add_f32_dpp v156, v156, v156 row_half_mirror row_mask:0xf bank_mask:0xf
    v_add_f32_dpp v157, v157, v157 row_half_mirror row_mask:0xf bank_mask:0xf
    v_add_f32_dpp v158, v158, v158 row_half_mirror row_mask:0xf bank_mask:0xf
    v_add_f32_dpp v159, v159, v159 row_half_mirror row_mask:0xf bank_mask:0xf
    buffer_load_dwordx4 v241, s[12:15], s68 offen offset:1024  lds
    v_add_f32_dpp v156, v156, v156 row_mirror row_mask:0xf bank_mask:0xf
    v_add_f32_dpp v157, v157, v157 row_mirror row_mask:0xf bank_mask:0xf
    v_add_f32_dpp v158, v158, v158 row_mirror row_mask:0xf bank_mask:0xf
    v_add_f32_dpp v159, v159, v159 row_mirror row_mask:0xf bank_mask:0xf
    v_mov_b32 v160, v156
    v_mov_b32 v161, v157
    v_mov_b32 v162, v158
    v_mov_b32 v163, v159
    v_permlane16_swap_b32 v156, v160
    buffer_load_dwordx4 v242, s[12:15], s68 offen offset:2048  lds
    v_permlane16_swap_b32 v157, v161
    v_permlane16_swap_b32 v158, v162
    v_permlane16_swap_b32 v159, v163
    v_add_f32 v156, v156, v160
    v_add_f32 v157, v157, v161
    v_add_f32 v158, v158, v162
    v_add_f32 v159, v159, v163
    v_mov_b32 v160, v156
    v_mov_b32 v161, v157
    v_mov_b32 v162, v158
    buffer_load_dwordx4 v243, s[12:15], s68 offen offset:3072  lds
    s_add_u32 m0, s90, 4096
    s_add_u32 s68, s69, 131072
    v_mov_b32 v163, v159
    v_permlane32_swap_b32 v156, v160
    v_permlane32_swap_b32 v157, v161
    v_permlane32_swap_b32 v158, v162
    v_permlane32_swap_b32 v159, v163
    v_add_f32 v156, v156, v160
    v_add_f32 v157, v157, v161
    v_add_f32 v158, v158, v162
    v_add_f32 v159, v159, v163
    v_mul_f32 v156, 3216550459, v156
    buffer_load_dwordx4 v240, s[12:15], s68 offen offset:0  lds
    v_mul_f32 v157, 3216550459, v157
    v_mul_f32 v158, 3216550459, v158
    v_mul_f32 v159, 3216550459, v159
    v_exp_f32 v156, v156
    v_exp_f32 v157, v157
    v_exp_f32 v158, v158
    v_exp_f32 v159, v159
    v_add_f32 v156, 1.0, v156
    v_add_f32 v157, 1.0, v157
    v_add_f32 v158, 1.0, v158
    buffer_load_dwordx4 v241, s[12:15], s68 offen offset:1024  lds
    v_add_f32 v159, 1.0, v159
    v_rcp_f32 v156, v156
    v_rcp_f32 v157, v157
    v_rcp_f32 v158, v158
    v_rcp_f32 v159, v159
    v_mov_b32 v160, v3
    v_writelane_b32 v160, 0, 0
    s_lshl_b32 s60, s97, 4
    s_add_u32 s60, s60, 16384
    buffer_store_dwordx4 v[156:159], v160, s[16:19], s60 offen sc1
    s_lshr_b32 s60, s56, 1
    buffer_load_dwordx4 v242, s[12:15], s68 offen offset:2048  lds
    s_mul_i32 s77, s60, 81920
    v_bfe_u32 v120, v1, 4, 1
    v_xor_b32 v120, s60, v120
    v_lshlrev_b32 v120, 4, v120
    v_bfe_u32 v121, v1, 2, 1
    v_lshl_add_u32 v120, v121, 3, v120
    v_bfe_u32 v121, v1, 3, 1
    v_lshl_add_u32 v120, v121, 2, v120
    v_and_b32 v121, 35, v1
    v_add_lshl_u32 v120, v120, v121, 4
    buffer_load_dwordx4 v243, s[12:15], s68 offen offset:3072  lds
    v_add_u32 v236, s77, v120
    s_lshl_b32 s61, s3, 2
    s_add_u32 s61, s61, s60
    s_lshl_b32 s60, s81, 1
    s_add_u32 s61, s61, s60
    s_lshl_b32 s61, s61, 4
    s_and_b32 s60, s56, 1
    s_add_u32 s95, s61, s60
    s_mul_i32 s95, s95, 6144
    s_add_u32 s95, s95, 1048576
    s_add_u32 m0, s91, 0
    s_add_u32 s68, s69, 128
    s_mul_i32 s60, s60, 6144
    s_add_u32 s77, s77, s60
    s_lshl_b32 s61, s61, 7
    s_add_u32 s61, s61, 14680064
    v_mov_b32 v238, v3
    s_sub_u32 s61, s61, 0
    v_lshl_add_u32 v239, v1, 7, s61
    s_mov_b32 vcc_lo, 65535
    s_mov_b32 vcc_hi, 0
    buffer_load_dwordx4 v240, s[12:15], s68 offen offset:0  lds
    v_cndmask_b32 v238, v238, v239, vcc
    s_lshr_b32 s60, s59, 1
    s_lshl_b32 s60, s60, 9
    s_add_u32 s60, s60, 14680064
    v_add_u32 v120, 16, v1
    v_bfe_u32 v120, v120, 2, 3
    v_lshlrev_b32 v120, 13, v120
    v_and_b32 v121, 3, v1
    v_lshl_add_u32 v120, v121, 7, v120
    v_add_u32 v120, s60, v120
    buffer_load_dwordx4 v241, s[12:15], s68 offen offset:1024  lds
    s_mov_b32 vcc_lo, 0xffff0000
    s_mov_b32 vcc_hi, 0xffff
    v_cndmask_b32 v238, v238, v120, vcc
    s_lshr_b32 s60, s59, 1
    s_lshl_b32 s60, s60, 1
    s_and_b32 s61, s56, 1
    s_add_u32 s60, s60, s61
    s_lshl_b32 s60, s60, 1
    s_add_u32 s60, s60, s81
    s_lshl_b32 s61, s3, 6
    buffer_load_dwordx4 v242, s[12:15], s68 offen offset:2048  lds
    s_add_u32 s72, s60, s61
    v_lshrrev_b32 v113, 5, v1
    v_lshlrev_b32 v113, 6, v113
    v_xor_b32 v112, v2, v113
    v_xor_b32 v113, 128, v112
    v_add_u32 v112, s94, v112
    v_add_u32 v113, s94, v113
    v_bfe_u32 v120, v1, 4, 1
    v_lshlrev_b32 v120, 1, v120
    v_bfe_u32 v121, v1, 1, 1
    buffer_load_dwordx4 v243, s[12:15], s68 offen offset:3072  lds
    s_add_u32 m0, s91, 4096
    s_add_u32 s68, s69, 131200
    v_or_b32 v120, v120, v121
    v_lshrrev_b32 v121, 5, v1
    v_lshlrev_b32 v121, 1, v121
    v_xor_b32 v121, v121, v120
    v_lshlrev_b32 v120, 9, v120
    v_bfe_u32 v122, v1, 2, 2
    v_lshl_add_u32 v120, v122, 4, v120
    v_bfe_u32 v122, v1, 0, 1
    v_lshl_add_u32 v120, v122, 3, v120
    buffer_load_dwordx4 v240, s[12:15], s68 offen offset:0  lds
    v_add_u32 v120, s94, v120
    v_lshl_add_u32 v124, v121, 6, v120
    v_xor_b32 v121, 1, v121
    v_lshl_add_u32 v125, v121, 6, v120
    s_lshl_b32 s60, s83, 3
    s_sub_i32 s60, s60, 64
    v_and_b32 v115, 31, v1
    v_cmp_gt_i32 vcc, s60, v115
    v_add_u32 v115, 4096, v2
    s_nop 0
    v_cndmask_b32 v114, v3, v115, vcc
    buffer_load_dwordx4 v241, s[12:15], s68 offen offset:1024  lds
    s_cmp_gt_u32 s83, 4
    s_cselect_b64 vcc, -1, 0
    v_cndmask_b32 v115, v3, v2, vcc
    s_lshl_b32 s60, s58, 6
    s_add_u32 s62, s60, s62
    s_mul_i32 s97, s62, 6144
    v_mov_b32 v118, s100
    v_mov_b32 v119, v3
    v_writelane_b32 v119, 0, 0
    v_cmp_gt_u32 vcc, 32, v1
    v_mov_b32 v82, 1107296256
    buffer_load_dwordx4 v242, s[12:15], s68 offen offset:2048  lds
    v_mov_b32 v84, 1119879168
    v_mov_b32 v83, 1023410176
    v_mov_b32 v85, 1009429163
    v_mov_b32 v152, 1117782016
    v_mov_b32 v153, 1011666125
    v_cndmask_b32 v82, v82, v84, vcc
    v_cndmask_b32 v83, v83, v85, vcc
    v_cndmask_b32 v152, v84, v152, vcc
    v_cndmask_b32 v153, v85, v153, vcc
    buffer_load_dwordx4 v243, s[12:15], s68 offen offset:3072  lds
    buffer_load_dwordx4 v[64:67], v2, s[16:19], s63 offen offset:0 sc1
    buffer_load_dwordx4 v[68:71], v2, s[16:19], s63 offen offset:1024 sc1
    buffer_load_dwordx4 v[72:75], v2, s[16:19], s63 offen offset:2048 sc1
    buffer_load_dwordx4 v[76:79], v2, s[16:19], s63 offen offset:3072 sc1
    s_add_u32 m0, s92, 0
    s_add_u32 s68, s69, 256
    buffer_load_dwordx4 v240, s[12:15], s68 offen offset:0  lds
    buffer_load_dwordx4 v241, s[12:15], s68 offen offset:1024  lds
    buffer_load_dwordx4 v242, s[12:15], s68 offen offset:2048  lds
    buffer_load_dwordx4 v243, s[12:15], s68 offen offset:3072  lds
    s_add_u32 m0, s92, 4096
    s_add_u32 s68, s69, 131328
    buffer_load_dwordx4 v240, s[12:15], s68 offen offset:0  lds
    buffer_load_dwordx4 v241, s[12:15], s68 offen offset:1024  lds
    buffer_load_dwordx4 v242, s[12:15], s68 offen offset:2048  lds
    buffer_load_dwordx4 v243, s[12:15], s68 offen offset:3072  lds
    s_waitcnt vmcnt(8)
    s_mov_b32 s99, 0
.Lsp_14:
    v_xor_b32 v80, s100, v65
    v_xor_b32 v81, s100, v67
    v_xor_b32 v116, s100, v69
    v_xor_b32 v117, s100, v71
    v_or3_b32 v80, v80, v116, v117
    v_xor_b32 v116, s100, v73
    v_xor_b32 v117, s100, v75
    v_or3_b32 v80, v80, v116, v117
    v_xor_b32 v116, s100, v77
    v_xor_b32 v117, s100, v79
    v_or3_b32 v80, v80, v116, v117
    v_or_b32 v80, v80, v81
    v_cmp_ne_u32 vcc, 0, v80
    s_nop 0
    s_cmp_eq_u64 vcc, 0
    s_cbranch_scc1 .Lsd_15
    buffer_load_dwordx4 v[64:67], v2, s[16:19], s63 offen offset:0 sc1
    buffer_load_dwordx4 v[68:71], v2, s[16:19], s63 offen offset:1024 sc1
    buffer_load_dwordx4 v[72:75], v2, s[16:19], s63 offen offset:2048 sc1
    buffer_load_dwordx4 v[76:79], v2, s[16:19], s63 offen offset:3072 sc1
    s_waitcnt vmcnt(0)
    s_add_u32 s99, s99, 1
    s_cmp_lt_u32 s99, 200000
    s_cbranch_scc1 .Lsp_14
.Lsd_15:
    v_add_f32 v80, v64, v68
    v_add_f32 v86, v72, v76
    v_add_f32 v80, v80, v86
    v_mov_b32 v87, v80
    v_add_f32 v81, v66, v70
    v_add_f32 v86, v74, v78
    v_permlane32_swap_b32 v80, v87
    v_add_f32 v81, v81, v86
    v_add_f32 v80, v80, v87
    v_mul_f32 v80, 985563898, v80
    v_fma_f32 v86, v64, v153, -v80
    v_mul_f32 v86, v86, v86
    v_fmac_f32 v81, v86, v152
    v_fma_f32 v86, v68, v85, -v80
    v_mul_f32 v86, v86, v86
    v_fmac_f32 v81, v86, v84
    v_fma_f32 v86, v72, v85, -v80
    v_mul_f32 v86, v86, v86
    v_fmac_f32 v81, v86, v84
    v_fma_f32 v86, v76, v83, -v80
    v_mul_f32 v86, v86, v86
    v_fmac_f32 v81, v86, v82
    v_mov_b32 v84, v81
    s_nop 1
    v_permlane32_swap_b32 v81, v84
    v_add_f32 v81, v81, v84
    v_mov_b32 v84, 925353388
    v_fmac_f32 v84, 985563898, v81
    v_rsq_f32 v81, v84
    s_add_u32 s60, s97, 1048576
    s_add_u32 s61, s60, 4096
    v_sub_f32 v80, v80, v126
    v_mul_f32 v80, v80, v81
    v_pk_fma_f32 v[16:17], v[16:17], v[80:81], v[80:81] op_sel:[0,1,0] op_sel_hi:[1,1,0] neg_lo:[0,0,1] neg_hi:[0,0,1]
    v_pk_fma_f32 v[18:19], v[18:19], v[80:81], v[80:81] op_sel:[0,1,0] op_sel_hi:[1,1,0] neg_lo:[0,0,1] neg_hi:[0,0,1]
    v_pk_fma_f32 v[20:21], v[20:21], v[80:81], v[80:81] op_sel:[0,1,0] op_sel_hi:[1,1,0] neg_lo:[0,0,1] neg_hi:[0,0,1]
    v_pk_fma_f32 v[22:23], v[22:23], v[80:81], v[80:81] op_sel:[0,1,0] op_sel_hi:[1,1,0] neg_lo:[0,0,1] neg_hi:[0,0,1]
    v_cvt_pk_bf16_f32 v88, v16, v17
    v_cvt_pk_bf16_f32 v89, v18, v19
    v_cvt_pk_bf16_f32 v90, v20, v21
    v_cvt_pk_bf16_f32 v91, v22, v23
    ds_write_b128 v112, v[88:91] offset:0
    v_pk_fma_f32 v[24:25], v[24:25], v[80:81], v[80:81] op_sel:[0,1,0] op_sel_hi:[1,1,0] neg_lo:[0,0,1] neg_hi:[0,0,1]
    v_pk_fma_f32 v[26:27], v[26:27], v[80:81], v[80:81] op_sel:[0,1,0] op_sel_hi:[1,1,0] neg_lo:[0,0,1] neg_hi:[0,0,1]
    v_pk_fma_f32 v[28:29], v[28:29], v[80:81], v[80:81] op_sel:[0,1,0] op_sel_hi:[1,1,0] neg_lo:[0,0,1] neg_hi:[0,0,1]
    v_pk_fma_f32 v[30:31], v[30:31], v[80:81], v[80:81] op_sel:[0,1,0] op_sel_hi:[1,1,0] neg_lo:[0,0,1] neg_hi:[0,0,1]
    v_cvt_pk_bf16_f32 v92, v24, v25
    v_cvt_pk_bf16_f32 v93, v26, v27
    v_cvt_pk_bf16_f32 v94, v28, v29
    v_cvt_pk_bf16_f32 v95, v30, v31
    ds_write_b128 v113, v[92:95] offset:1024
    ds_read_b64_tr_b16 v[128:129], v124 offset:0
    ds_read_b64_tr_b16 v[130:131], v125 offset:0
    ds_read_b64_tr_b16 v[136:137], v124 offset:256
    ds_read_b64_tr_b16 v[138:139], v125 offset:256
    v_pk_fma_f32 v[32:33], v[32:33], v[80:81], v[80:81] op_sel:[0,1,0] op_sel_hi:[1,1,0] neg_lo:[0,0,1] neg_hi:[0,0,1]
    v_pk_fma_f32 v[34:35], v[34:35], v[80:81], v[80:81] op_sel:[0,1,0] op_sel_hi:[1,1,0] neg_lo:[0,0,1] neg_hi:[0,0,1]
    v_pk_fma_f32 v[36:37], v[36:37], v[80:81], v[80:81] op_sel:[0,1,0] op_sel_hi:[1,1,0] neg_lo:[0,0,1] neg_hi:[0,0,1]
    v_pk_fma_f32 v[38:39], v[38:39], v[80:81], v[80:81] op_sel:[0,1,0] op_sel_hi:[1,1,0] neg_lo:[0,0,1] neg_hi:[0,0,1]
    v_cvt_pk_bf16_f32 v96, v32, v33
    v_cvt_pk_bf16_f32 v97, v34, v35
    v_cvt_pk_bf16_f32 v98, v36, v37
    v_cvt_pk_bf16_f32 v99, v38, v39
    ds_write_b128 v112, v[96:99] offset:2048
    v_pk_fma_f32 v[40:41], v[40:41], v[80:81], v[80:81] op_sel:[0,1,0] op_sel_hi:[1,1,0] neg_lo:[0,0,1] neg_hi:[0,0,1]
    v_pk_fma_f32 v[42:43], v[42:43], v[80:81], v[80:81] op_sel:[0,1,0] op_sel_hi:[1,1,0] neg_lo:[0,0,1] neg_hi:[0,0,1]
    v_pk_fma_f32 v[44:45], v[44:45], v[80:81], v[80:81] op_sel:[0,1,0] op_sel_hi:[1,1,0] neg_lo:[0,0,1] neg_hi:[0,0,1]
    v_pk_fma_f32 v[46:47], v[46:47], v[80:81], v[80:81] op_sel:[0,1,0] op_sel_hi:[1,1,0] neg_lo:[0,0,1] neg_hi:[0,0,1]
    v_cvt_pk_bf16_f32 v100, v40, v41
    v_cvt_pk_bf16_f32 v101, v42, v43
    v_cvt_pk_bf16_f32 v102, v44, v45
    v_cvt_pk_bf16_f32 v103, v46, v47
    ds_write_b128 v113, v[100:103] offset:3072
    ds_read_b64_tr_b16 v[132:133], v124 offset:2048
    ds_read_b64_tr_b16 v[134:135], v125 offset:2048
    ds_read_b64_tr_b16 v[140:141], v124 offset:2304
    ds_read_b64_tr_b16 v[142:143], v125 offset:2304
    s_waitcnt lgkmcnt(8)
    buffer_store_dwordx4 v[128:131], v2, s[16:19], s60 offen offset:0 sc1
    s_waitcnt lgkmcnt(6)
    buffer_store_dwordx4 v[136:139], v2, s[16:19], s60 offen offset:2048 sc1
    v_pk_fma_f32 v[48:49], v[48:49], v[80:81], v[80:81] op_sel:[0,1,0] op_sel_hi:[1,1,0] neg_lo:[0,0,1] neg_hi:[0,0,1]
    v_pk_fma_f32 v[50:51], v[50:51], v[80:81], v[80:81] op_sel:[0,1,0] op_sel_hi:[1,1,0] neg_lo:[0,0,1] neg_hi:[0,0,1]
    v_pk_fma_f32 v[52:53], v[52:53], v[80:81], v[80:81] op_sel:[0,1,0] op_sel_hi:[1,1,0] neg_lo:[0,0,1] neg_hi:[0,0,1]
    v_pk_fma_f32 v[54:55], v[54:55], v[80:81], v[80:81] op_sel:[0,1,0] op_sel_hi:[1,1,0] neg_lo:[0,0,1] neg_hi:[0,0,1]
    v_cvt_pk_bf16_f32 v104, v48, v49
    v_cvt_pk_bf16_f32 v105, v50, v51
    v_cvt_pk_bf16_f32 v106, v52, v53
    v_cvt_pk_bf16_f32 v107, v54, v55
    ds_write_b128 v112, v[104:107] offset:4096
    v_pk_fma_f32 v[56:57], v[56:57], v[80:81], v[80:81] op_sel:[0,1,0] op_sel_hi:[1,1,0] neg_lo:[0,0,1] neg_hi:[0,0,1]
    v_pk_fma_f32 v[58:59], v[58:59], v[80:81], v[80:81] op_sel:[0,1,0] op_sel_hi:[1,1,0] neg_lo:[0,0,1] neg_hi:[0,0,1]
    v_pk_fma_f32 v[60:61], v[60:61], v[80:81], v[80:81] op_sel:[0,1,0] op_sel_hi:[1,1,0] neg_lo:[0,0,1] neg_hi:[0,0,1]
    v_pk_fma_f32 v[62:63], v[62:63], v[80:81], v[80:81] op_sel:[0,1,0] op_sel_hi:[1,1,0] neg_lo:[0,0,1] neg_hi:[0,0,1]
    v_cvt_pk_bf16_f32 v108, v56, v57
    v_cvt_pk_bf16_f32 v109, v58, v59
    v_cvt_pk_bf16_f32 v110, v60, v61
    v_cvt_pk_bf16_f32 v111, v62, v63
    ds_write_b128 v113, v[108:111] offset:5120
    ds_read_b64_tr_b16 v[144:145], v124 offset:4096
    ds_read_b64_tr_b16 v[146:147], v125 offset:4096
    ds_read_b64_tr_b16 v[148:149], v124 offset:4352
    ds_read_b64_tr_b16 v[150:151], v125 offset:4352
    s_waitcnt lgkmcnt(8)
    buffer_store_dwordx4 v[132:135], v115, s[16:19], s60 offen offset:1024 sc1
    s_waitcnt lgkmcnt(6)
    buffer_store_dwordx4 v[140:143], v115, s[16:19], s60 offen offset:3072 sc1
    s_lshl_b32 s97, s62, 7
    s_add_u32 s97, s97, 14680064
    s_waitcnt lgkmcnt(2)
    buffer_store_dwordx4 v[144:147], v114, s[16:19], s60 offen offset:0 sc1
    s_waitcnt lgkmcnt(0)
    buffer_store_dwordx4 v[148:151], v114, s[16:19], s60 offen offset:1024 sc1
    s_add_u32 m0, s93, 0
    s_add_u32 s68, s69, 384
    v_add_u32 v248, s90, v244
    v_add_u32 v249, s90, v245
    v_add_u32 v250, s90, v246
    v_add_u32 v251, s90, v247
    ds_read_b128 a[0:3], v248 offset:0
    v_xor_b32 v248, 4096, v248
    ds_read_b128 a[8:11], v249 offset:0
    v_xor_b32 v249, 4096, v249
    buffer_load_dwordx4 v240, s[12:15], s68 offen offset:0  lds
    ds_read_b128 a[16:19], v250 offset:0
    v_xor_b32 v250, 4096, v250
    ds_read_b128 a[24:27], v251 offset:0
    v_xor_b32 v251, 4096, v251
    ds_read_b128 a[4:7], v248 offset:0
    buffer_load_dwordx4 v241, s[12:15], s68 offen offset:1024  lds
    ds_read_b128 a[12:15], v249 offset:0
    ds_read_b128 a[20:23], v250 offset:0
    ds_read_b128 a[28:31], v251 offset:0
    buffer_load_dwordx4 v242, s[12:15], s68 offen offset:2048  lds
    v_add_u32 v248, s91, v244
    v_add_u32 v249, s91, v245
    v_add_u32 v250, s91, v246
    v_add_u32 v251, s91, v247
    s_waitcnt lgkmcnt(7)
    ds_read_b128 a[32:35], v248 offset:0
    v_xor_b32 v248, 4096, v248
    ds_read_b128 a[40:43], v249 offset:0
    v_xor_b32 v249, 4096, v249
    buffer_load_dwordx4 v243, s[12:15], s68 offen offset:3072  lds
    s_add_u32 m0, s93, 4096
    s_add_u32 s68, s69, 131456
    ds_read_b128 a[48:51], v250 offset:0
    v_xor_b32 v250, 4096, v250
    ds_read_b128 a[56:59], v251 offset:0
    v_xor_b32 v251, 4096, v251
    ds_read_b128 a[36:39], v248 offset:0
    buffer_load_dwordx4 v240, s[12:15], s68 offen offset:0  lds
    ds_read_b128 a[44:47], v249 offset:0
    ds_read_b128 a[52:55], v250 offset:0
    ds_read_b128 a[60:63], v251 offset:0
    buffer_load_dwordx4 v241, s[12:15], s68 offen offset:1024  lds
    v_add_u32 v248, s92, v244
    v_add_u32 v249, s92, v245
    v_add_u32 v250, s92, v246
    v_add_u32 v251, s92, v247
    s_waitcnt vmcnt(12) lgkmcnt(7)
    ds_read_b128 a[64:67], v248 offset:0
    v_xor_b32 v248, 4096, v248
    ds_read_b128 a[72:75], v249 offset:0
    v_xor_b32 v249, 4096, v249
    buffer_load_dwordx4 v242, s[12:15], s68 offen offset:2048  lds
    ds_read_b128 a[80:83], v250 offset:0
    v_xor_b32 v250, 4096, v250
    ds_read_b128 a[88:91], v251 offset:0
    v_xor_b32 v251, 4096, v251
    ds_read_b128 a[68:71], v248 offset:0
    buffer_load_dwordx4 v243, s[12:15], s68 offen offset:3072  lds
    ds_read_b128 a[76:79], v249 offset:0
    ds_read_b128 a[84:87], v250 offset:0
    ds_read_b128 a[92:95], v251 offset:0
    s_waitcnt vmcnt(8)
    buffer_store_dword v118, v119, s[16:19], s97 offen sc1
    s_lshl_b32 s78, s57, 2
    s_add_u32 s78, s78, s56
    s_mul_i32 s78, s78, 45056
    s_lshl_b32 s60, s82, 9
    s_add_u32 s78, s78, s60
    s_add_u32 s78, s78, 7340032
    v_mov_b32 v176, -1
    v_mov_b32 v177, -1
    v_mov_b32 v178, -1
    v_mov_b32 v179, -1
    buffer_store_dwordx4 v[176:179], v2, s[16:19], s78 offen offset:0 sc1
    buffer_store_dwordx4 v[176:179], v2, s[16:19], s78 offen offset:1024 sc1
    buffer_store_dwordx4 v[176:179], v2, s[16:19], s78 offen offset:2048 sc1
    buffer_store_dwordx4 v[176:179], v115, s[16:19], s78 offen offset:3072 sc1
    s_add_u32 s78, s78, 4096
    buffer_store_dwordx4 v[176:179], v115, s[16:19], s78 offen offset:0 sc1
    buffer_store_dwordx4 v[176:179], v115, s[16:19], s78 offen offset:1024 sc1
    s_add_u32 m0, s94, 0
    s_add_u32 s68, s69, 512
    buffer_load_dwordx4 v240, s[12:15], s68 offen offset:0  lds
    buffer_load_dwordx4 v241, s[12:15], s68 offen offset:1024  lds
    buffer_load_dwordx4 v242, s[12:15], s68 offen offset:2048  lds
    buffer_load_dwordx4 v243, s[12:15], s68 offen offset:3072  lds
    s_add_u32 m0, s94, 4096
    s_add_u32 s68, s69, 131584
    buffer_load_dwordx4 v240, s[12:15], s68 offen offset:0  lds
    buffer_load_dwordx4 v241, s[12:15], s68 offen offset:1024  lds
    buffer_load_dwordx4 v242, s[12:15], s68 offen offset:2048  lds
    buffer_load_dwordx4 v243, s[12:15], s68 offen offset:3072  lds
    s_waitcnt lgkmcnt(0)
    s_add_u32 m0, s90, 0
    s_add_u32 s68, s69, 640
    buffer_load_dwordx4 v240, s[12:15], s68 offen offset:0  lds
    buffer_load_dwordx4 v241, s[12:15], s68 offen offset:1024  lds
    buffer_load_dwordx4 v242, s[12:15], s68 offen offset:2048  lds
    buffer_load_dwordx4 v243, s[12:15], s68 offen offset:3072  lds
    s_add_u32 m0, s90, 4096
    s_add_u32 s68, s69, 131712
    buffer_load_dwordx4 v240, s[12:15], s68 offen offset:0  lds
    buffer_load_dwordx4 v241, s[12:15], s68 offen offset:1024  lds
    buffer_load_dwordx4 v242, s[12:15], s68 offen offset:2048  lds
    buffer_load_dwordx4 v243, s[12:15], s68 offen offset:3072  lds
    s_add_u32 m0, s91, 0
    s_add_u32 s68, s69, 768
    buffer_load_dwordx4 v240, s[12:15], s68 offen offset:0  lds
    buffer_load_dwordx4 v241, s[12:15], s68 offen offset:1024  lds
    buffer_load_dwordx4 v242, s[12:15], s68 offen offset:2048  lds
    buffer_load_dwordx4 v243, s[12:15], s68 offen offset:3072  lds
    s_add_u32 m0, s91, 4096
    s_add_u32 s68, s69, 131840
    buffer_load_dwordx4 v240, s[12:15], s68 offen offset:0  lds
    buffer_load_dwordx4 v241, s[12:15], s68 offen offset:1024  lds
    buffer_load_dwordx4 v242, s[12:15], s68 offen offset:2048  lds
    buffer_load_dwordx4 v243, s[12:15], s68 offen offset:3072  lds
    s_waitcnt vmcnt(24)
    s_add_u32 s97, s97, 327680
    buffer_store_dword v118, v119, s[16:19], s97 offen sc1
    s_add_u32 m0, s92, 0
    s_add_u32 s68, s69, 896
    buffer_load_dwordx4 v240, s[12:15], s68 offen offset:0  lds
    buffer_load_dwordx4 v241, s[12:15], s68 offen offset:1024  lds
    buffer_load_dwordx4 v242, s[12:15], s68 offen offset:2048  lds
    buffer_load_dwordx4 v243, s[12:15], s68 offen offset:3072  lds
    s_add_u32 m0, s92, 4096
    s_add_u32 s68, s69, 131968
    buffer_load_dwordx4 v240, s[12:15], s68 offen offset:0  lds
    buffer_load_dwordx4 v241, s[12:15], s68 offen offset:1024  lds
    buffer_load_dwordx4 v242, s[12:15], s68 offen offset:2048  lds
    buffer_load_dwordx4 v243, s[12:15], s68 offen offset:3072  lds
    v_add_u32 v248, s93, v244
    v_add_u32 v249, s93, v245
    v_add_u32 v250, s93, v246
    v_add_u32 v251, s93, v247
    ds_read_b128 a[96:99], v248 offset:0
    v_xor_b32 v248, 4096, v248
    ds_read_b128 a[104:107], v249 offset:0
    v_xor_b32 v249, 4096, v249
    ds_read_b128 a[112:115], v250 offset:0
    v_xor_b32 v250, 4096, v250
    ds_read_b128 a[120:123], v251 offset:0
    v_xor_b32 v251, 4096, v251
    ds_read_b128 a[100:103], v248 offset:0
    ds_read_b128 a[108:111], v249 offset:0
    ds_read_b128 a[116:119], v250 offset:0
    ds_read_b128 a[124:127], v251 offset:0
    v_add_u32 v248, s94, v244
    v_add_u32 v249, s94, v245
    v_add_u32 v250, s94, v246
    v_add_u32 v251, s94, v247
    s_waitcnt vmcnt(25) lgkmcnt(7)
    ds_read_b128 a[128:131], v248 offset:0
    v_xor_b32 v248, 4096, v248
    ds_read_b128 a[136:139], v249 offset:0
    v_xor_b32 v249, 4096, v249
    ds_read_b128 a[144:147], v250 offset:0
    v_xor_b32 v250, 4096, v250
    ds_read_b128 a[152:155], v251 offset:0
    v_xor_b32 v251, 4096, v251
    ds_read_b128 a[132:135], v248 offset:0
    ds_read_b128 a[140:143], v249 offset:0
    ds_read_b128 a[148:151], v250 offset:0
    ds_read_b128 a[156:159], v251 offset:0
    v_add_u32 v248, s90, v244
    v_add_u32 v249, s90, v245
    v_add_u32 v250, s90, v246
    v_add_u32 v251, s90, v247
    s_waitcnt vmcnt(17) lgkmcnt(7)
    ds_read_b128 a[160:163], v248 offset:0
    v_xor_b32 v248, 4096, v248
    ds_read_b128 a[168:171], v249 offset:0
    v_xor_b32 v249, 4096, v249
    ds_read_b128 a[176:179], v250 offset:0
    v_xor_b32 v250, 4096, v250
    ds_read_b128 a[184:187], v251 offset:0
    v_xor_b32 v251, 4096, v251
    ds_read_b128 a[164:167], v248 offset:0
    ds_read_b128 a[172:175], v249 offset:0
    ds_read_b128 a[180:183], v250 offset:0
    ds_read_b128 a[188:191], v251 offset:0
    v_add_u32 v248, s91, v244
    v_add_u32 v249, s91, v245
    v_add_u32 v250, s91, v246
    v_add_u32 v251, s91, v247
    s_waitcnt vmcnt(9) lgkmcnt(7)
    ds_read_b128 a[192:195], v248 offset:0
    v_xor_b32 v248, 4096, v248
    ds_read_b128 a[200:203], v249 offset:0
    v_xor_b32 v249, 4096, v249
    ds_read_b128 a[208:211], v250 offset:0
    v_xor_b32 v250, 4096, v250
    ds_read_b128 a[216:219], v251 offset:0
    v_xor_b32 v251, 4096, v251
    ds_read_b128 a[196:199], v248 offset:0
    ds_read_b128 a[204:207], v249 offset:0
    ds_read_b128 a[212:215], v250 offset:0
    ds_read_b128 a[220:223], v251 offset:0
    v_add_u32 v248, s92, v244
    v_add_u32 v249, s92, v245
    v_add_u32 v250, s92, v246
    v_add_u32 v251, s92, v247
    s_waitcnt vmcnt(0) lgkmcnt(7)
    ds_read_b128 a[224:227], v248 offset:0
    v_xor_b32 v248, 4096, v248
    ds_read_b128 a[232:235], v249 offset:0
    v_xor_b32 v249, 4096, v249
    ds_read_b128 a[240:243], v250 offset:0
    v_xor_b32 v250, 4096, v250
    ds_read_b128 a[248:251], v251 offset:0
    v_xor_b32 v251, 4096, v251
    ds_read_b128 a[228:231], v248 offset:0
    ds_read_b128 a[236:239], v249 offset:0
    ds_read_b128 a[244:247], v250 offset:0
    ds_read_b128 a[252:255], v251 offset:0
    buffer_load_dword v239, v238, s[16:19], 0 offen sc1
    s_mov_b32 s101, 0
.LG_3:
    s_mov_b32 s58, s3
    s_lshr_b32 s89, s56, 1
    s_and_b32 s62, s72, 63
    s_mul_i32 s82, s3, 12
    s_sub_u32 s82, s82, 2
    s_cmp_eq_u32 s3, 0
    s_cselect_b32 s82, 0, s82
    s_cselect_b32 s83, 10, 12
    s_cmp_eq_u32 s3, 7
    s_cselect_b32 s83, 4, s83
    s_lshl_b32 s60, s83, 3
    s_sub_i32 s60, s60, 64
    v_and_b32 v186, 31, v1
    v_cmp_gt_i32 vcc, s60, v186
    s_lshl_b32 s98, s89, 1
    s_add_u32 s63, s98, 8
    v_cndmask_b32 v237, v3, v2, vcc
    s_cmp_gt_u32 s83, 4
    s_cselect_b64 vcc, -1, 0
    v_cndmask_b32 v227, v3, v2, vcc
    s_cmp_lt_u32 s63, s83
    s_cselect_b64 vcc, -1, 0
    v_cndmask_b32 v203, v3, v2, vcc
    s_lshl_b32 s60, s62, 5
    v_add_lshl_u32 v186, v186, s60, 1
    global_load_ushort v202, v186, s[44:45]
    s_add_u32 s98, s98, s82
    s_lshl_b32 s98, s98, 9
    s_mul_i32 s86, s62, 45056
    s_add_u32 s86, s86, s98
    s_add_u32 s63, s86, 4194304
    v_and_b32 v222, 31, v1
    v_lshlrev_b32 v222, 2, v222
    s_waitcnt lgkmcnt(0)
    s_waitcnt vmcnt(9)
    s_cmp_ge_u32 s2, 128
    s_cbranch_scc1 .Lgp_16
    s_waitcnt vmcnt(0)
.Lgp_16:
    v_cmp_ne_u32 vcc, s100, v239
    s_nop 0
    s_and_b32 vcc_hi, vcc_hi, 0xffff
    s_or_b32 s98, vcc_lo, vcc_hi
    s_cbranch_scc0 .Lgd_17
    s_mov_b32 s99, 0
.Lpoll_18:
    buffer_load_dword v239, v238, s[16:19], 0 offen sc1
    s_waitcnt vmcnt(0)
    v_cmp_ne_u32 vcc, s100, v239
    s_nop 0
    s_and_b32 vcc_hi, vcc_hi, 65535
    s_or_b32 s98, vcc_lo, vcc_hi
    s_cbranch_scc0 .Lpd_19
    s_add_u32 s99, s99, 1
    s_cmp_lt_u32 s99, 200000
    s_cbranch_scc1 .Lpoll_18
.Lpd_19:
.Lgd_17:
    s_barrier
    s_add_u32 m0, s77, 0
    s_add_u32 s68, s95, 0
    buffer_load_dwordx4 v2, s[16:19], s68 offen offset:0 sc1 lds
    buffer_load_dwordx4 v227, s[16:19], s68 offen offset:1024 sc1 lds
    buffer_load_dwordx4 v2, s[16:19], s68 offen offset:2048 sc1 lds
    buffer_load_dwordx4 v227, s[16:19], s68 offen offset:3072 sc1 lds
    s_add_u32 m0, s77, 4096
    s_add_u32 s68, s95, 4096
    buffer_load_dwordx4 v237, s[16:19], s68 offen offset:0 sc1 lds
    buffer_load_dwordx4 v237, s[16:19], s68 offen offset:1024 sc1 lds
    s_lshl_b32 s97, s59, 11
    s_add_u32 s97, s97, 14745600
    s_lshl_b32 s60, s72, 7
    s_add_u32 s60, s60, 14942208
    s_sub_u32 s61, s60, 8192
    s_cmp_eq_u32 s58, 0
    s_cselect_b32 s61, s60, s61
    v_mov_b32 v234, v3
    s_sub_u32 s97, s97, 0
    v_lshl_add_u32 v235, v1, 7, s97
    s_mov_b32 vcc_lo, 65535
    s_mov_b32 vcc_hi, 0
    v_cndmask_b32 v234, v234, v235, vcc
    v_writelane_b32 v234, s60, 16
    v_writelane_b32 v234, s61, 17
    s_lshr_b32 s60, s59, 1
    s_lshl_b32 s60, s60, 9
    s_add_u32 s60, s60, 15007744
    s_add_u32 m0, s77, 12288
    s_add_u32 s68, s95, 12288
    v_bfe_u32 v186, v1, 2, 3
    v_lshlrev_b32 v186, 13, v186
    v_and_b32 v187, 3, v1
    v_lshl_add_u32 v186, v187, 7, v186
    v_add_u32 v186, s60, v186
    s_mov_b32 vcc_lo, 0
    s_mov_b32 vcc_hi, -1
    v_cndmask_b32 v234, v234, v186, vcc
    v_mov_b32 v220, s100
    v_mov_b32 v221, v3
    v_writelane_b32 v221, 0, 0
    v_lshrrev_b32 v186, 3, v1
    v_lshlrev_b32 v186, 10, v186
    v_bfe_u32 v187, v1, 4, 1
    v_lshlrev_b32 v187, 2, v187
    buffer_load_dwordx4 v2, s[16:19], s68 offen offset:0 sc1 lds
    v_and_b32 v188, 7, v1
    v_xor_b32 v187, v187, v188
    v_lshl_add_u32 v244, v187, 4, v186
    v_add_u32 v245, 7168, v244
    v_add_u32 v246, 14336, v244
    v_add_u32 v247, 21504, v244
    s_mul_i32 s73, s56, 180224
    s_lshl_b32 s60, s58, 7
    s_add_u32 s73, s73, s60
    v_lshrrev_b32 v224, 5, v1
    v_lshlrev_b32 v224, 10, v224
    v_bfe_u32 v225, v1, 2, 2
    v_lshl_add_u32 v224, v225, 7, v224
    v_bfe_u32 v225, v1, 4, 1
    v_lshl_add_u32 v224, v225, 5, v224
    buffer_load_dwordx4 v227, s[16:19], s68 offen offset:1024 sc1 lds
    v_and_b32 v225, 3, v1
    v_lshl_add_u32 v224, v225, 3, v224
    v_bfe_u32 v225, v1, 3, 1
    v_lshlrev_b32 v225, 6, v225
    v_add_u32 v224, s96, v224
    v_add_u32 v228, v224, v225
    v_xor_b32 v225, 64, v225
    v_add_u32 v229, v224, v225
    v_lshrrev_b32 v224, 3, v1
    v_mul_u32_u24 v224, 1024, v224
    v_and_b32 v225, 7, v1
    v_lshrrev_b32 v210, 4, v1
    v_xor_b32 v225, v225, v210
    v_lshlrev_b32 v225, 4, v225
    v_add_u32 v210, v225, v224
    buffer_load_dwordx4 v2, s[16:19], s68 offen offset:2048 sc1 lds
    v_xor_b32 v225, 64, v225
    v_add_u32 v211, v225, v224
    v_add_u32 v212, 14336, v210
    v_add_u32 v213, 21504, v211
    v_add_u32 v211, 7168, v211
    s_add_u32 s60, s96, 4096
    v_and_b32 v224, 31, v1
    v_lshlrev_b32 v224, 7, v224
    v_add_u32 v224, s60, v224
    v_bfe_u32 v225, v1, 1, 3
    v_lshrrev_b32 v214, 5, v1
    v_xor_b32 v225, v225, v214
    v_lshlrev_b32 v225, 4, v225
    v_xor_b32 v214, 0, v225
    v_add_u32 v214, v214, v224
    buffer_load_dwordx4 v227, s[16:19], s68 offen offset:3072 sc1 lds
    s_add_u32 m0, s77, 16384
    s_add_u32 s68, s95, 16384
    v_xor_b32 v215, 32, v225
    v_add_u32 v215, v215, v224
    v_xor_b32 v216, 64, v225
    v_add_u32 v216, v216, v224
    v_xor_b32 v217, 96, v225
    v_add_u32 v217, v217, v224
    s_add_u32 s60, s96, 12288
    v_bfe_u32 v224, v1, 4, 1
    v_lshlrev_b32 v224, 1, v224
    v_bfe_u32 v225, v1, 1, 1
    v_or_b32 v224, v224, v225
    v_lshrrev_b32 v225, 5, v1
    v_lshlrev_b32 v225, 1, v225
    v_xor_b32 v225, v225, v224
    v_lshlrev_b32 v224, 9, v224
    buffer_load_dwordx4 v237, s[16:19], s68 offen offset:0 sc1 lds
    v_bfe_u32 v226, v1, 2, 2
    v_lshl_add_u32 v224, v226, 4, v224
    v_bfe_u32 v226, v1, 0, 1
    v_lshl_add_u32 v224, v226, 3, v224
    v_add_u32 v224, s60, v224
    v_lshl_add_u32 v218, v225, 6, v224
    v_xor_b32 v225, 1, v225
    v_lshl_add_u32 v219, v225, 6, v224
    s_lshl_b32 s78, s58, 16
    s_lshl_b32 s60, s56, 8
    s_add_u32 s78, s78, s60
    s_lshl_b32 s79, s59, 17
    s_lshl_b32 s60, s56, 15
    s_add_u32 s79, s79, s60
    s_add_u32 s79, s79, 10485760
    buffer_load_dwordx4 v237, s[16:19], s68 offen offset:1024 sc1 lds
    s_waitcnt vmcnt(6)
    s_barrier
    ds_read_b128 v[112:115], v236 offset:0
    ds_read_b128 v[116:119], v236 offset:1024
    ds_read_b128 v[120:123], v236 offset:4096
    ds_read_b128 v[124:127], v236 offset:2048
    ds_read_b128 v[128:131], v236 offset:3072
    ds_read_b128 v[132:135], v236 offset:5120
    s_waitcnt lgkmcnt(3)
    v_mfma_f32_32x32x16_bf16 v[16:31], v[112:115], a[0:3], 0
    ds_read_b128 v[136:139], v236 offset:6144
    v_mfma_f32_32x32x16_bf16 v[32:47], v[112:115], a[4:7], 0
    ds_read_b128 v[140:143], v236 offset:7168
    v_mfma_f32_32x32x16_bf16 v[48:63], v[116:119], a[0:3], 0
    ds_read_b128 v[144:147], v236 offset:10240
    s_add_u32 m0, s77, 40960
    s_add_u32 s68, s95, 24576
    v_mfma_f32_32x32x16_bf16 v[64:79], v[116:119], a[4:7], 0
    ds_read_b128 v[148:151], v236 offset:8192
    buffer_load_dwordx4 v2, s[16:19], s68 offen offset:0 sc1 lds
    v_mfma_f32_32x32x16_bf16 v[80:95], v[120:123], a[0:3], 0
    ds_read_b128 v[152:155], v236 offset:9216
    buffer_load_dwordx4 v227, s[16:19], s68 offen offset:1024 sc1 lds
    v_mfma_f32_32x32x16_bf16 v[96:111], v[120:123], a[4:7], 0
    ds_read_b128 v[156:159], v236 offset:11264
    buffer_load_dwordx4 v2, s[16:19], s68 offen offset:2048 sc1 lds
    s_waitcnt lgkmcnt(6)
    v_mfma_f32_32x32x16_bf16 v[16:31], v[124:127], a[8:11], v[16:31]
    v_mfma_f32_32x32x16_bf16 v[32:47], v[124:127], a[12:15], v[32:47]
    buffer_load_dwordx4 v227, s[16:19], s68 offen offset:3072 sc1 lds
    s_add_u32 m0, s77, 45056
    s_add_u32 s68, s95, 28672
    v_mfma_f32_32x32x16_bf16 v[48:63], v[128:131], a[8:11], v[48:63]
    v_mfma_f32_32x32x16_bf16 v[64:79], v[128:131], a[12:15], v[64:79]
    buffer_load_dwordx4 v237, s[16:19], s68 offen offset:0 sc1 lds
    v_mfma_f32_32x32x16_bf16 v[80:95], v[132:135], a[8:11], v[80:95]
    v_mfma_f32_32x32x16_bf16 v[96:111], v[132:135], a[12:15], v[96:111]
    buffer_load_dwordx4 v237, s[16:19], s68 offen offset:1024 sc1 lds
    s_waitcnt vmcnt(6) lgkmcnt(0)
    s_barrier
    v_mfma_f32_32x32x16_bf16 v[16:31], v[136:139], a[16:19], v[16:31]
    ds_read_b128 v[112:115], v236 offset:12288
    v_mfma_f32_32x32x16_bf16 v[32:47], v[136:139], a[20:23], v[32:47]
    ds_read_b128 v[116:119], v236 offset:13312
    v_mfma_f32_32x32x16_bf16 v[48:63], v[140:143], a[16:19], v[48:63]
    s_add_u32 m0, s77, 53248
    s_add_u32 s68, s95, 36864
    ds_read_b128 v[120:123], v236 offset:16384
    buffer_load_dwordx4 v2, s[16:19], s68 offen offset:0 sc1 lds
    v_mfma_f32_32x32x16_bf16 v[64:79], v[140:143], a[20:23], v[64:79]
    buffer_load_dwordx4 v227, s[16:19], s68 offen offset:1024 sc1 lds
    ds_read_b128 v[124:127], v236 offset:14336
    buffer_load_dwordx4 v2, s[16:19], s68 offen offset:2048 sc1 lds
    v_mfma_f32_32x32x16_bf16 v[80:95], v[144:147], a[16:19], v[80:95]
    buffer_load_dwordx4 v227, s[16:19], s68 offen offset:3072 sc1 lds
    s_add_u32 m0, s77, 57344
    s_add_u32 s68, s95, 40960
    ds_read_b128 v[128:131], v236 offset:15360
    buffer_load_dwordx4 v237, s[16:19], s68 offen offset:0 sc1 lds
    v_mfma_f32_32x32x16_bf16 v[96:111], v[144:147], a[20:23], v[96:111]
    buffer_load_dwordx4 v237, s[16:19], s68 offen offset:1024 sc1 lds
    ds_read_b128 v[132:135], v236 offset:17408
    s_add_u32 m0, s77, 0
    s_add_u32 s68, s95, 49152
    v_mfma_f32_32x32x16_bf16 v[16:31], v[148:151], a[24:27], v[16:31]
    buffer_load_dwordx4 v2, s[16:19], s68 offen offset:0 sc1 lds
    v_mfma_f32_32x32x16_bf16 v[32:47], v[148:151], a[28:31], v[32:47]
    buffer_load_dwordx4 v227, s[16:19], s68 offen offset:1024 sc1 lds
    v_mfma_f32_32x32x16_bf16 v[48:63], v[152:155], a[24:27], v[48:63]
    buffer_load_dwordx4 v2, s[16:19], s68 offen offset:2048 sc1 lds
    v_mfma_f32_32x32x16_bf16 v[64:79], v[152:155], a[28:31], v[64:79]
    buffer_load_dwordx4 v227, s[16:19], s68 offen offset:3072 sc1 lds
    s_add_u32 m0, s77, 4096
    s_add_u32 s68, s95, 53248
    v_mfma_f32_32x32x16_bf16 v[80:95], v[156:159], a[24:27], v[80:95]
    buffer_load_dwordx4 v237, s[16:19], s68 offen offset:0 sc1 lds
    v_mfma_f32_32x32x16_bf16 v[96:111], v[156:159], a[28:31], v[96:111]
    buffer_load_dwordx4 v237, s[16:19], s68 offen offset:1024 sc1 lds
    s_waitcnt lgkmcnt(3)
    v_mfma_f32_32x32x16_bf16 v[16:31], v[112:115], a[32:35], v[16:31]
    ds_read_b128 v[136:139], v236 offset:18432
    v_mfma_f32_32x32x16_bf16 v[32:47], v[112:115], a[36:39], v[32:47]
    ds_read_b128 v[140:143], v236 offset:19456
    v_mfma_f32_32x32x16_bf16 v[48:63], v[116:119], a[32:35], v[48:63]
    ds_read_b128 v[144:147], v236 offset:22528
    s_add_u32 m0, s96, 24576
    s_add_u32 s68, s73, 131072
    v_mfma_f32_32x32x16_bf16 v[64:79], v[116:119], a[36:39], v[64:79]
    ds_read_b128 v[148:151], v236 offset:20480
    buffer_load_dwordx4 v244, s[28:31], s68 offen offset:0 lds
    v_mfma_f32_32x32x16_bf16 v[80:95], v[120:123], a[32:35], v[80:95]
    ds_read_b128 v[152:155], v236 offset:21504
    buffer_load_dwordx4 v245, s[28:31], s68 offen offset:1024 lds
    v_mfma_f32_32x32x16_bf16 v[96:111], v[120:123], a[36:39], v[96:111]
    ds_read_b128 v[156:159], v236 offset:23552
    buffer_load_dwordx4 v246, s[28:31], s68 offen offset:2048 lds
    s_waitcnt lgkmcnt(6)
    v_mfma_f32_32x32x16_bf16 v[16:31], v[124:127], a[40:43], v[16:31]
    v_mfma_f32_32x32x16_bf16 v[32:47], v[124:127], a[44:47], v[32:47]
    buffer_load_dwordx4 v247, s[28:31], s68 offen offset:3072 lds
    s_add_u32 m0, s96, 28672
    s_add_u32 s68, s73, 163840
    v_mfma_f32_32x32x16_bf16 v[48:63], v[128:131], a[40:43], v[48:63]
    v_mfma_f32_32x32x16_bf16 v[64:79], v[128:131], a[44:47], v[64:79]
    buffer_load_dwordx4 v244, s[28:31], s68 offen offset:0 lds
    v_mfma_f32_32x32x16_bf16 v[80:95], v[132:135], a[40:43], v[80:95]
    v_mfma_f32_32x32x16_bf16 v[96:111], v[132:135], a[44:47], v[96:111]
    buffer_load_dwordx4 v245, s[28:31], s68 offen offset:1024 lds
    s_waitcnt vmcnt(18) lgkmcnt(0)
    s_barrier
    v_mfma_f32_32x32x16_bf16 v[16:31], v[136:139], a[48:51], v[16:31]
    ds_read_b128 v[112:115], v236 offset:40960
    v_mfma_f32_32x32x16_bf16 v[32:47], v[136:139], a[52:55], v[32:47]
    ds_read_b128 v[116:119], v236 offset:41984
    v_mfma_f32_32x32x16_bf16 v[48:63], v[140:143], a[48:51], v[48:63]
    ds_read_b128 v[120:123], v236 offset:45056
    s_add_u32 m0, s77, 12288
    s_add_u32 s68, s95, 61440
    v_mfma_f32_32x32x16_bf16 v[64:79], v[140:143], a[52:55], v[64:79]
    ds_read_b128 v[124:127], v236 offset:43008
    buffer_load_dwordx4 v2, s[16:19], s68 offen offset:0 sc1 lds
    v_mfma_f32_32x32x16_bf16 v[80:95], v[144:147], a[48:51], v[80:95]
    ds_read_b128 v[128:131], v236 offset:44032
    buffer_load_dwordx4 v227, s[16:19], s68 offen offset:1024 sc1 lds
    v_mfma_f32_32x32x16_bf16 v[96:111], v[144:147], a[52:55], v[96:111]
    ds_read_b128 v[132:135], v236 offset:46080
    buffer_load_dwordx4 v2, s[16:19], s68 offen offset:2048 sc1 lds
    v_mfma_f32_32x32x16_bf16 v[16:31], v[148:151], a[56:59], v[16:31]
    v_mfma_f32_32x32x16_bf16 v[32:47], v[148:151], a[60:63], v[32:47]
    buffer_load_dwordx4 v227, s[16:19], s68 offen offset:3072 sc1 lds
    s_add_u32 m0, s77, 16384
    s_add_u32 s68, s95, 65536
    v_mfma_f32_32x32x16_bf16 v[48:63], v[152:155], a[56:59], v[48:63]
    v_mfma_f32_32x32x16_bf16 v[64:79], v[152:155], a[60:63], v[64:79]
    buffer_load_dwordx4 v237, s[16:19], s68 offen offset:0 sc1 lds
    v_mfma_f32_32x32x16_bf16 v[80:95], v[156:159], a[56:59], v[80:95]
    v_mfma_f32_32x32x16_bf16 v[96:111], v[156:159], a[60:63], v[96:111]
    buffer_load_dwordx4 v237, s[16:19], s68 offen offset:1024 sc1 lds
    s_cmp_eq_u32 s101, 0
    s_cbranch_scc1 .Lnf_20
    s_waitcnt vmcnt(42)
    buffer_store_dword v220, v221, s[16:19], s101 offen sc1
.Lnf_20:
    s_waitcnt lgkmcnt(3)
    v_mfma_f32_32x32x16_bf16 v[16:31], v[112:115], a[64:67], v[16:31]
    ds_read_b128 v[136:139], v236 offset:47104
    v_mfma_f32_32x32x16_bf16 v[32:47], v[112:115], a[68:71], v[32:47]
    ds_read_b128 v[140:143], v236 offset:48128
    v_mfma_f32_32x32x16_bf16 v[48:63], v[116:119], a[64:67], v[48:63]
    ds_read_b128 v[144:147], v236 offset:51200
    s_waitcnt vmcnt(10)
    ds_read_b64_tr_b16 a[0:1], v228 offset:24576
    ds_read_b64_tr_b16 a[2:3], v228 offset:25088
    ds_read_b64_tr_b16 a[4:5], v229 offset:24576
    ds_read_b64_tr_b16 a[6:7], v229 offset:25088
    v_mfma_f32_32x32x16_bf16 v[64:79], v[116:119], a[68:71], v[64:79]
    ds_read_b128 v[148:151], v236 offset:49152
    s_waitcnt vmcnt(8)
    ds_read_b64_tr_b16 a[8:9], v228 offset:26624
    ds_read_b64_tr_b16 a[10:11], v228 offset:27136
    ds_read_b64_tr_b16 a[12:13], v229 offset:26624
    ds_read_b64_tr_b16 a[14:15], v229 offset:27136
    v_mfma_f32_32x32x16_bf16 v[80:95], v[120:123], a[64:67], v[80:95]
    ds_read_b128 v[152:155], v236 offset:50176
    s_waitcnt vmcnt(6) lgkmcnt(11)
    ds_read_b64_tr_b16 a[16:17], v228 offset:28672
    ds_read_b64_tr_b16 a[18:19], v228 offset:29184
    ds_read_b64_tr_b16 a[20:21], v229 offset:28672
    ds_read_b64_tr_b16 a[22:23], v229 offset:29184
    v_mfma_f32_32x32x16_bf16 v[96:111], v[120:123], a[68:71], v[96:111]
    s_waitcnt lgkmcnt(0)
    ds_read_b128 v[156:159], v236 offset:52224
    v_mfma_f32_32x32x16_bf16 v[16:31], v[124:127], a[72:75], v[16:31]
    s_add_u32 m0, s96, 24576
    s_add_u32 s68, s73, 0
    v_mfma_f32_32x32x16_bf16 v[32:47], v[124:127], a[76:79], v[32:47]
    v_mfma_f32_32x32x16_bf16 v[48:63], v[128:131], a[72:75], v[48:63]
    buffer_load_dwordx4 v244, s[28:31], s68 offen offset:0 lds
    v_mfma_f32_32x32x16_bf16 v[64:79], v[128:131], a[76:79], v[64:79]
    v_mfma_f32_32x32x16_bf16 v[80:95], v[132:135], a[72:75], v[80:95]
    buffer_load_dwordx4 v245, s[28:31], s68 offen offset:1024 lds
    v_mfma_f32_32x32x16_bf16 v[96:111], v[132:135], a[76:79], v[96:111]
    buffer_load_dwordx4 v246, s[28:31], s68 offen offset:2048 lds
    s_waitcnt lgkmcnt(0)
    s_barrier
    v_mfma_f32_32x32x16_bf16 v[16:31], v[136:139], a[80:83], v[16:31]
    ds_read_b128 v[112:115], v236 offset:53248
    v_mfma_f32_32x32x16_bf16 v[32:47], v[136:139], a[84:87], v[32:47]
    ds_read_b128 v[116:119], v236 offset:54272
    v_mfma_f32_32x32x16_bf16 v[48:63], v[140:143], a[80:83], v[48:63]
    ds_read_b128 v[120:123], v236 offset:57344
    s_add_u32 m0, s96, 27648
    s_add_u32 s68, s73, 24576
    v_mfma_f32_32x32x16_bf16 v[64:79], v[140:143], a[84:87], v[64:79]
    ds_read_b128 v[124:127], v236 offset:55296
    buffer_load_dwordx4 v244, s[28:31], s68 offen offset:0 lds
    v_mfma_f32_32x32x16_bf16 v[80:95], v[144:147], a[80:83], v[80:95]
    s_add_u32 m0, s77, 40960
    s_add_u32 s68, s95, 73728
    ds_read_b128 v[128:131], v236 offset:56320
    v_mfma_f32_32x32x16_bf16 v[96:111], v[144:147], a[84:87], v[96:111]
    buffer_load_dwordx4 v2, s[16:19], s68 offen offset:0 sc1 lds
    ds_read_b128 v[132:135], v236 offset:58368
    buffer_load_dwordx4 v227, s[16:19], s68 offen offset:1024 sc1 lds
    v_mfma_f32_32x32x16_bf16 v[16:31], v[148:151], a[88:91], v[16:31]
    v_mfma_f32_32x32x16_bf16 v[32:47], v[148:151], a[92:95], v[32:47]
    buffer_load_dwordx4 v2, s[16:19], s68 offen offset:2048 sc1 lds
    v_mfma_f32_32x32x16_bf16 v[48:63], v[152:155], a[88:91], v[48:63]
    buffer_load_dwordx4 v227, s[16:19], s68 offen offset:3072 sc1 lds
    s_add_u32 m0, s77, 45056
    s_add_u32 s68, s95, 77824
    v_mfma_f32_32x32x16_bf16 v[64:79], v[152:155], a[92:95], v[64:79]
    v_mfma_f32_32x32x16_bf16 v[80:95], v[156:159], a[88:91], v[80:95]
    buffer_load_dwordx4 v237, s[16:19], s68 offen offset:0 sc1 lds
    v_mfma_f32_32x32x16_bf16 v[96:111], v[156:159], a[92:95], v[96:111]
    buffer_load_dwordx4 v237, s[16:19], s68 offen offset:1024 sc1 lds
    s_waitcnt lgkmcnt(3)
    v_mfma_f32_32x32x16_bf16 v[16:31], v[112:115], a[96:99], v[16:31]
    ds_read_b128 v[136:139], v236 offset:59392
    v_mfma_f32_32x32x16_bf16 v[32:47], v[112:115], a[100:103], v[32:47]
    ds_read_b128 v[140:143], v236 offset:60416
    v_mfma_f32_32x32x16_bf16 v[48:63], v[116:119], a[96:99], v[48:63]
    ds_read_b128 v[144:147], v236 offset:63488
    s_add_u32 m0, s96, 28672
    s_add_u32 s68, s73, 32768
    v_mfma_f32_32x32x16_bf16 v[64:79], v[116:119], a[100:103], v[64:79]
    ds_read_b128 v[148:151], v236 offset:61440
    buffer_load_dwordx4 v244, s[28:31], s68 offen offset:0 lds
    v_mfma_f32_32x32x16_bf16 v[80:95], v[120:123], a[96:99], v[80:95]
    ds_read_b128 v[152:155], v236 offset:62464
    buffer_load_dwordx4 v245, s[28:31], s68 offen offset:1024 lds
    v_mfma_f32_32x32x16_bf16 v[96:111], v[120:123], a[100:103], v[96:111]
    ds_read_b128 v[156:159], v236 offset:64512
    buffer_load_dwordx4 v246, s[28:31], s68 offen offset:2048 lds
    s_waitcnt lgkmcnt(6)
    v_mfma_f32_32x32x16_bf16 v[16:31], v[124:127], a[104:107], v[16:31]
    v_mfma_f32_32x32x16_bf16 v[32:47], v[124:127], a[108:111], v[32:47]
    buffer_load_dwordx4 v247, s[28:31], s68 offen offset:3072 lds
    s_add_u32 m0, s96, 32768
    s_add_u32 s68, s73, 65536
    v_mfma_f32_32x32x16_bf16 v[48:63], v[128:131], a[104:107], v[48:63]
    v_mfma_f32_32x32x16_bf16 v[64:79], v[128:131], a[108:111], v[64:79]
    buffer_load_dwordx4 v244, s[28:31], s68 offen offset:0 lds
    v_mfma_f32_32x32x16_bf16 v[80:95], v[132:135], a[104:107], v[80:95]
    v_mfma_f32_32x32x16_bf16 v[96:111], v[132:135], a[108:111], v[96:111]
    s_lshl_b32 s60, s59, 8
    s_add_u32 s60, s60, 16384
    buffer_load_dword v240, v222, s[16:19], s60 offen sc1
    buffer_load_dword v242, v222, s[16:19], s60 offen offset:128 sc1
    s_lshl_b32 s60, s62, 7
    s_add_u32 s60, s60, 16384
    buffer_load_dword v241, v222, s[16:19], s60 offen sc1
    s_waitcnt lgkmcnt(0)
    s_barrier
    v_mfma_f32_32x32x16_bf16 v[16:31], v[136:139], a[112:115], v[16:31]
    ds_read_b128 v[112:115], v236 offset:0
    v_mfma_f32_32x32x16_bf16 v[32:47], v[136:139], a[116:119], v[32:47]
    ds_read_b128 v[116:119], v236 offset:1024
    v_mfma_f32_32x32x16_bf16 v[48:63], v[140:143], a[112:115], v[48:63]
    ds_read_b128 v[120:123], v236 offset:4096
    s_add_u32 m0, s96, 33792
    s_add_u32 s68, s73, 73728
    v_mfma_f32_32x32x16_bf16 v[64:79], v[140:143], a[116:119], v[64:79]
    ds_read_b128 v[124:127], v236 offset:2048
    buffer_load_dwordx4 v244, s[28:31], s68 offen offset:0 lds
    v_mfma_f32_32x32x16_bf16 v[80:95], v[144:147], a[112:115], v[80:95]
    s_add_u32 m0, s77, 53248
    s_add_u32 s68, s95, 86016
    ds_read_b128 v[128:131], v236 offset:3072
    v_mfma_f32_32x32x16_bf16 v[96:111], v[144:147], a[116:119], v[96:111]
    buffer_load_dwordx4 v2, s[16:19], s68 offen offset:0 sc1 lds
    ds_read_b128 v[132:135], v236 offset:5120
    buffer_load_dwordx4 v227, s[16:19], s68 offen offset:1024 sc1 lds
    v_mfma_f32_32x32x16_bf16 v[16:31], v[148:151], a[120:123], v[16:31]
    v_mfma_f32_32x32x16_bf16 v[32:47], v[148:151], a[124:127], v[32:47]
    buffer_load_dwordx4 v2, s[16:19], s68 offen offset:2048 sc1 lds
    v_mfma_f32_32x32x16_bf16 v[48:63], v[152:155], a[120:123], v[48:63]
    buffer_load_dwordx4 v227, s[16:19], s68 offen offset:3072 sc1 lds
    s_add_u32 m0, s77, 57344
    s_add_u32 s68, s95, 90112
    v_mfma_f32_32x32x16_bf16 v[64:79], v[152:155], a[124:127], v[64:79]
    v_mfma_f32_32x32x16_bf16 v[80:95], v[156:159], a[120:123], v[80:95]
    buffer_load_dwordx4 v237, s[16:19], s68 offen offset:0 sc1 lds
    v_mfma_f32_32x32x16_bf16 v[96:111], v[156:159], a[124:127], v[96:111]
    buffer_load_dwordx4 v237, s[16:19], s68 offen offset:1024 sc1 lds
    s_waitcnt lgkmcnt(3)
    v_mfma_f32_32x32x16_bf16 v[16:31], v[112:115], a[128:131], v[16:31]
    ds_read_b128 v[136:139], v236 offset:6144
    v_mfma_f32_32x32x16_bf16 v[32:47], v[112:115], a[132:135], v[32:47]
    ds_read_b128 v[140:143], v236 offset:7168
    v_mfma_f32_32x32x16_bf16 v[48:63], v[116:119], a[128:131], v[48:63]
    ds_read_b128 v[144:147], v236 offset:10240
    s_add_u32 m0, s96, 34816
    s_add_u32 s68, s73, 81920
    v_mfma_f32_32x32x16_bf16 v[64:79], v[116:119], a[132:135], v[64:79]
    ds_read_b128 v[148:151], v236 offset:8192
    buffer_load_dwordx4 v244, s[28:31], s68 offen offset:0 lds
    v_mfma_f32_32x32x16_bf16 v[80:95], v[120:123], a[128:131], v[80:95]
    ds_read_b128 v[152:155], v236 offset:9216
    buffer_load_dwordx4 v245, s[28:31], s68 offen offset:1024 lds
    v_mfma_f32_32x32x16_bf16 v[96:111], v[120:123], a[132:135], v[96:111]
    buffer_load_dwordx4 v246, s[28:31], s68 offen offset:2048 lds
    ds_read_b128 v[156:159], v236 offset:11264
    s_waitcnt lgkmcnt(6)
    v_mfma_f32_32x32x16_bf16 v[16:31], v[124:127], a[136:139], v[16:31]
    buffer_load_dwordx4 v247, s[28:31], s68 offen offset:3072 lds
    s_add_u32 m0, s96, 38912
    s_add_u32 s68, s73, 114688
    v_mfma_f32_32x32x16_bf16 v[32:47], v[124:127], a[140:143], v[32:47]
    v_mfma_f32_32x32x16_bf16 v[48:63], v[128:131], a[136:139], v[48:63]
    buffer_load_dwordx4 v244, s[28:31], s68 offen offset:0 lds
    v_mfma_f32_32x32x16_bf16 v[64:79], v[128:131], a[140:143], v[64:79]
    v_mfma_f32_32x32x16_bf16 v[80:95], v[132:135], a[136:139], v[80:95]
    buffer_load_dwordx4 v245, s[28:31], s68 offen offset:1024 lds
    v_mfma_f32_32x32x16_bf16 v[96:111], v[132:135], a[140:143], v[96:111]
    buffer_load_dword v235, v234, s[16:19], 0 offen sc1
    s_waitcnt vmcnt(32) lgkmcnt(0)
    s_barrier
    v_mfma_f32_32x32x16_bf16 v[16:31], v[136:139], a[144:147], v[16:31]
    ds_read_b128 v[112:115], v236 offset:12288
    v_mfma_f32_32x32x16_bf16 v[32:47], v[136:139], a[148:151], v[32:47]
    ds_read_b128 v[116:119], v236 offset:13312
    v_mfma_f32_32x32x16_bf16 v[48:63], v[140:143], a[144:147], v[48:63]
    ds_read_b128 v[120:123], v236 offset:16384
    v_mfma_f32_32x32x16_bf16 v[64:79], v[140:143], a[148:151], v[64:79]
    ds_read_b128 v[124:127], v236 offset:14336
    v_mfma_f32_32x32x16_bf16 v[80:95], v[144:147], a[144:147], v[80:95]
    ds_read_b128 v[128:131], v236 offset:15360
    v_mfma_f32_32x32x16_bf16 v[96:111], v[144:147], a[148:151], v[96:111]
    ds_read_b128 v[132:135], v236 offset:17408
    v_mfma_f32_32x32x16_bf16 v[16:31], v[148:151], a[152:155], v[16:31]
    v_mfma_f32_32x32x16_bf16 v[32:47], v[148:151], a[156:159], v[32:47]
    v_mfma_f32_32x32x16_bf16 v[48:63], v[152:155], a[152:155], v[48:63]
    v_mfma_f32_32x32x16_bf16 v[64:79], v[152:155], a[156:159], v[64:79]
    v_mfma_f32_32x32x16_bf16 v[80:95], v[156:159], a[152:155], v[80:95]
    v_mfma_f32_32x32x16_bf16 v[96:111], v[156:159], a[156:159], v[96:111]
    s_waitcnt lgkmcnt(3)
    v_mfma_f32_32x32x16_bf16 v[16:31], v[112:115], a[160:163], v[16:31]
    ds_read_b128 v[136:139], v236 offset:18432
    v_mfma_f32_32x32x16_bf16 v[32:47], v[112:115], a[164:167], v[32:47]
    ds_read_b128 v[140:143], v236 offset:19456
    v_mfma_f32_32x32x16_bf16 v[48:63], v[116:119], a[160:163], v[48:63]
    ds_read_b128 v[144:147], v236 offset:22528
    s_waitcnt vmcnt(30)
    ds_read_b64_tr_b16 a[24:25], v228 offset:24576
    ds_read_b64_tr_b16 a[26:27], v228 offset:25088
    ds_read_b64_tr_b16 a[28:29], v229 offset:24576
    ds_read_b64_tr_b16 a[30:31], v229 offset:25088
    v_mfma_f32_32x32x16_bf16 v[64:79], v[116:119], a[164:167], v[64:79]
    s_waitcnt vmcnt(28)
    ds_read_b64_tr_b16 a[32:33], v228 offset:26624
    ds_read_b64_tr_b16 a[34:35], v228 offset:27136
    ds_read_b64_tr_b16 a[36:37], v229 offset:26624
    ds_read_b64_tr_b16 a[38:39], v229 offset:27136
    ds_read_b128 v[148:151], v236 offset:20480
    s_waitcnt vmcnt(20) lgkmcnt(11)
    ds_read_b64_tr_b16 a[40:41], v228 offset:28672
    ds_read_b64_tr_b16 a[42:43], v228 offset:29184
    ds_read_b64_tr_b16 a[44:45], v229 offset:28672
    ds_read_b64_tr_b16 a[46:47], v229 offset:29184
    v_mfma_f32_32x32x16_bf16 v[80:95], v[120:123], a[160:163], v[80:95]
    s_waitcnt vmcnt(18) lgkmcnt(11)
    ds_read_b64_tr_b16 a[48:49], v228 offset:30720
    ds_read_b64_tr_b16 a[50:51], v228 offset:31232
    ds_read_b64_tr_b16 a[52:53], v229 offset:30720
    ds_read_b64_tr_b16 a[54:55], v229 offset:31232
    ds_read_b128 v[152:155], v236 offset:21504
    s_waitcnt vmcnt(13) lgkmcnt(11)
    ds_read_b64_tr_b16 a[56:57], v228 offset:32768
    ds_read_b64_tr_b16 a[58:59], v228 offset:33280
    ds_read_b64_tr_b16 a[60:61], v229 offset:32768
    ds_read_b64_tr_b16 a[62:63], v229 offset:33280
    v_mfma_f32_32x32x16_bf16 v[96:111], v[120:123], a[164:167], v[96:111]
    s_waitcnt vmcnt(5) lgkmcnt(11)
    ds_read_b64_tr_b16 a[64:65], v228 offset:34816
    ds_read_b64_tr_b16 a[66:67], v228 offset:35328
    ds_read_b64_tr_b16 a[68:69], v229 offset:34816
    ds_read_b64_tr_b16 a[70:71], v229 offset:35328
    ds_read_b128 v[156:159], v236 offset:23552
    v_mfma_f32_32x32x16_bf16 v[16:31], v[124:127], a[168:171], v[16:31]
    s_waitcnt vmcnt(3) lgkmcnt(11)
    ds_read_b64_tr_b16 a[72:73], v228 offset:36864
    ds_read_b64_tr_b16 a[74:75], v228 offset:37376
    ds_read_b64_tr_b16 a[76:77], v229 offset:36864
    ds_read_b64_tr_b16 a[78:79], v229 offset:37376
    v_mfma_f32_32x32x16_bf16 v[32:47], v[124:127], a[172:175], v[32:47]
    s_waitcnt vmcnt(1) lgkmcnt(11)
    ds_read_b64_tr_b16 a[80:81], v228 offset:38912
    ds_read_b64_tr_b16 a[82:83], v228 offset:39424
    ds_read_b64_tr_b16 a[84:85], v229 offset:38912
    ds_read_b64_tr_b16 a[86:87], v229 offset:39424
    v_mfma_f32_32x32x16_bf16 v[48:63], v[128:131], a[168:171], v[48:63]
    s_waitcnt lgkmcnt(0)
    v_mfma_f32_32x32x16_bf16 v[64:79], v[128:131], a[172:175], v[64:79]
    s_add_u32 m0, s96, 24576
    s_add_u32 s68, s78, 0
    v_mfma_f32_32x32x16_bf16 v[80:95], v[132:135], a[168:171], v[80:95]
    buffer_load_dwordx4 v210, s[20:23], s68 offen offset:0 lds
    v_mfma_f32_32x32x16_bf16 v[96:111], v[132:135], a[172:175], v[96:111]
    buffer_load_dwordx4 v211, s[20:23], s68 offen offset:1024 lds
    s_barrier
    s_waitcnt vmcnt(2)
    s_mov_b32 s99, 0
.Llp_21:
    v_cmp_ne_u32 vcc, s100, v235
    s_nop 0
    s_and_b32 s98, vcc_lo, 262143
    s_or_b32 s98, s98, vcc_hi
    s_cbranch_scc0 .Lld_22
    buffer_load_dword v235, v234, s[16:19], 0 offen sc1
    s_waitcnt vmcnt(0)
    s_add_u32 s99, s99, 1
    s_cmp_lt_u32 s99, 200000
    s_cbranch_scc1 .Llp_21
.Lld_22:
    v_mfma_f32_32x32x16_bf16 v[16:31], v[136:139], a[176:179], v[16:31]
    ds_read_b128 v[112:115], v236 offset:40960
    v_mfma_f32_32x32x16_bf16 v[32:47], v[136:139], a[180:183], v[32:47]
    ds_read_b128 v[116:119], v236 offset:41984
    v_mfma_f32_32x32x16_bf16 v[48:63], v[140:143], a[176:179], v[48:63]
    ds_read_b128 v[120:123], v236 offset:45056
    s_add_u32 m0, s96, 24576
    s_add_u32 s68, s78, 0
    v_mfma_f32_32x32x16_bf16 v[64:79], v[140:143], a[180:183], v[64:79]
    ds_read_b128 v[124:127], v236 offset:43008
    buffer_load_dwordx4 v212, s[20:23], s68 offen offset:2048 lds
    v_mfma_f32_32x32x16_bf16 v[80:95], v[144:147], a[176:179], v[80:95]
    ds_read_b128 v[128:131], v236 offset:44032
    buffer_load_dwordx4 v213, s[20:23], s68 offen offset:3072 lds
    s_add_u32 m0, s96, 28672
    s_add_u32 s68, s78, 32768
    v_mfma_f32_32x32x16_bf16 v[96:111], v[144:147], a[180:183], v[96:111]
    buffer_load_dwordx4 v210, s[20:23], s68 offen offset:0 lds
    ds_read_b128 v[132:135], v236 offset:46080
    v_mfma_f32_32x32x16_bf16 v[16:31], v[148:151], a[184:187], v[16:31]
    buffer_load_dwordx4 v211, s[20:23], s68 offen offset:1024 lds
    v_mfma_f32_32x32x16_bf16 v[32:47], v[148:151], a[188:191], v[32:47]
    v_mfma_f32_32x32x16_bf16 v[48:63], v[152:155], a[184:187], v[48:63]
    buffer_load_dwordx4 v212, s[20:23], s68 offen offset:2048 lds
    v_mfma_f32_32x32x16_bf16 v[64:79], v[152:155], a[188:191], v[64:79]
    v_mfma_f32_32x32x16_bf16 v[80:95], v[156:159], a[184:187], v[80:95]
    buffer_load_dwordx4 v213, s[20:23], s68 offen offset:3072 lds
    v_mfma_f32_32x32x16_bf16 v[96:111], v[156:159], a[188:191], v[96:111]
    buffer_load_dwordx4 v[190:193], v2, s[16:19], s63 offen sc1
    buffer_load_dwordx4 v[194:197], v227, s[16:19], s63 offen offset:2048 sc1
    s_add_u32 s63, s63, 4096
    buffer_load_dwordx4 v[198:201], v203, s[16:19], s63 offen sc1
    s_waitcnt lgkmcnt(3)
    v_mfma_f32_32x32x16_bf16 v[16:31], v[112:115], a[192:195], v[16:31]
    ds_read_b128 v[136:139], v236 offset:47104
    v_mfma_f32_32x32x16_bf16 v[32:47], v[112:115], a[196:199], v[32:47]
    ds_read_b128 v[140:143], v236 offset:48128
    v_mfma_f32_32x32x16_bf16 v[48:63], v[116:119], a[192:195], v[48:63]
    ds_read_b128 v[144:147], v236 offset:51200
    v_mfma_f32_32x32x16_bf16 v[64:79], v[116:119], a[196:199], v[64:79]
    s_add_u32 m0, s96, 32768
    s_add_u32 s68, s79, 0
    ds_read_b128 v[148:151], v236 offset:49152
    v_mfma_f32_32x32x16_bf16 v[80:95], v[120:123], a[192:195], v[80:95]
    buffer_load_dwordx4 v2, s[16:19], s68 offen offset:0 sc1 lds
    ds_read_b128 v[152:155], v236 offset:50176
    v_mfma_f32_32x32x16_bf16 v[96:111], v[120:123], a[196:199], v[96:111]
    buffer_load_dwordx4 v2, s[16:19], s68 offen offset:1024 sc1 lds
    ds_read_b128 v[156:159], v236 offset:52224
    s_waitcnt lgkmcnt(6)
    v_mfma_f32_32x32x16_bf16 v[16:31], v[124:127], a[200:203], v[16:31]
    v_mfma_f32_32x32x16_bf16 v[32:47], v[124:127], a[204:207], v[32:47]
    buffer_load_dwordx4 v2, s[16:19], s68 offen offset:2048 sc1 lds
    v_mfma_f32_32x32x16_bf16 v[48:63], v[128:131], a[200:203], v[48:63]
    v_mfma_f32_32x32x16_bf16 v[64:79], v[128:131], a[204:207], v[64:79]
    buffer_load_dwordx4 v2, s[16:19], s68 offen offset:3072 sc1 lds
    s_add_u32 m0, s96, 36864
    s_add_u32 s68, s79, 4096
    v_mfma_f32_32x32x16_bf16 v[80:95], v[132:135], a[200:203], v[80:95]
    v_mfma_f32_32x32x16_bf16 v[96:111], v[132:135], a[204:207], v[96:111]
    buffer_load_dwordx4 v2, s[16:19], s68 offen offset:0 sc1 lds
    s_waitcnt lgkmcnt(0)
    s_barrier
    v_mfma_f32_32x32x16_bf16 v[16:31], v[136:139], a[208:211], v[16:31]
    ds_read_b128 v[112:115], v236 offset:53248
    v_mfma_f32_32x32x16_bf16 v[32:47], v[136:139], a[212:215], v[32:47]
    ds_read_b128 v[116:119], v236 offset:54272
    ds_read_b128 v[120:123], v236 offset:57344
    v_mfma_f32_32x32x16_bf16 v[48:63], v[140:143], a[208:211], v[48:63]
    ds_read_b128 v[124:127], v236 offset:55296
    v_mfma_f32_32x32x16_bf16 v[64:79], v[140:143], a[212:215], v[64:79]
    ds_read_b128 v[128:131], v236 offset:56320
    ds_read_b128 v[132:135], v236 offset:58368
    v_mfma_f32_32x32x16_bf16 v[80:95], v[144:147], a[208:211], v[80:95]
    s_add_u32 m0, s96, 36864
    s_add_u32 s68, s79, 4096
    ds_read_b128 v[160:163], v236 offset:59392
    v_mfma_f32_32x32x16_bf16 v[96:111], v[144:147], a[212:215], v[96:111]
    ds_read_b128 v[164:167], v236 offset:60416
    ds_read_b128 v[168:171], v236 offset:63488
    buffer_load_dwordx4 v2, s[16:19], s68 offen offset:1024 sc1 lds
    v_mfma_f32_32x32x16_bf16 v[16:31], v[148:151], a[216:219], v[16:31]
    ds_read_b128 v[172:175], v236 offset:61440
    v_mfma_f32_32x32x16_bf16 v[32:47], v[148:151], a[220:223], v[32:47]
    ds_read_b128 v[176:179], v236 offset:62464
    ds_read_b128 v[180:183], v236 offset:64512
    buffer_load_dwordx4 v2, s[16:19], s68 offen offset:2048 sc1 lds
    v_mfma_f32_32x32x16_bf16 v[48:63], v[152:155], a[216:219], v[48:63]
    v_mfma_f32_32x32x16_bf16 v[64:79], v[152:155], a[220:223], v[64:79]
    v_mfma_f32_32x32x16_bf16 v[80:95], v[156:159], a[216:219], v[80:95]
    v_mfma_f32_32x32x16_bf16 v[96:111], v[156:159], a[220:223], v[96:111]
    buffer_load_dwordx4 v2, s[16:19], s68 offen offset:3072 sc1 lds
    s_xor_b32 s60, s56, 2
    s_mul_i32 s60, s60, 40960
    v_add_u32 v186, s96, v2
    v_add_u32 v187, s60, v2
    s_waitcnt lgkmcnt(11)
    v_mfma_f32_32x32x16_bf16 v[32:47], v[112:115], a[228:231], v[32:47]
    s_waitcnt lgkmcnt(8)
    v_mfma_f32_32x32x16_bf16 v[32:47], v[124:127], a[236:239], v[32:47]
    s_waitcnt lgkmcnt(5)
    v_mfma_f32_32x32x16_bf16 v[32:47], v[160:163], a[244:247], v[32:47]
    s_waitcnt lgkmcnt(2)
    v_mfma_f32_32x32x16_bf16 v[32:47], v[172:175], a[252:255], v[32:47]
    v_mfma_f32_32x32x16_bf16 v[64:79], v[116:119], a[228:231], v[64:79]
    v_mfma_f32_32x32x16_bf16 v[64:79], v[128:131], a[236:239], v[64:79]
    v_mfma_f32_32x32x16_bf16 v[64:79], v[164:167], a[244:247], v[64:79]
    s_waitcnt lgkmcnt(1)
    v_mfma_f32_32x32x16_bf16 v[64:79], v[176:179], a[252:255], v[64:79]
    v_mfma_f32_32x32x16_bf16 v[96:111], v[120:123], a[228:231], v[96:111]
    v_mfma_f32_32x32x16_bf16 v[96:111], v[132:135], a[236:239], v[96:111]
    s_nop 4
    ds_write_b128 v186, v[40:43] offset:2048
    v_mfma_f32_32x32x16_bf16 v[96:111], v[168:171], a[244:247], v[96:111]
    s_waitcnt lgkmcnt(1)
    v_mfma_f32_32x32x16_bf16 v[96:111], v[180:183], a[252:255], v[96:111]
    ds_write_b128 v186, v[44:47] offset:3072
    v_mfma_f32_32x32x16_bf16 v[16:31], v[112:115], a[224:227], v[16:31]
    v_mfma_f32_32x32x16_bf16 v[16:31], v[124:127], a[232:235], v[16:31]
    ds_write_b128 v186, v[72:75] offset:6144
    v_mfma_f32_32x32x16_bf16 v[16:31], v[160:163], a[240:243], v[16:31]
    v_mfma_f32_32x32x16_bf16 v[16:31], v[172:175], a[248:251], v[16:31]
    ds_write_b128 v186, v[76:79] offset:7168
    v_mfma_f32_32x32x16_bf16 v[48:63], v[116:119], a[224:227], v[48:63]
    v_mfma_f32_32x32x16_bf16 v[48:63], v[128:131], a[232:235], v[48:63]
    s_nop 2
    ds_write_b128 v186, v[104:107] offset:10240
    v_mfma_f32_32x32x16_bf16 v[48:63], v[164:167], a[240:243], v[48:63]
    v_mfma_f32_32x32x16_bf16 v[48:63], v[176:179], a[248:251], v[48:63]
    ds_write_b128 v186, v[108:111] offset:11264
    v_mfma_f32_32x32x16_bf16 v[80:95], v[120:123], a[224:227], v[80:95]
    v_mfma_f32_32x32x16_bf16 v[80:95], v[132:135], a[232:235], v[80:95]
    ds_write_b128 v186, v[24:27] offset:0
    v_mfma_f32_32x32x16_bf16 v[80:95], v[168:171], a[240:243], v[80:95]
    v_mfma_f32_32x32x16_bf16 v[80:95], v[180:183], a[248:251], v[80:95]
    ds_write_b128 v186, v[28:31] offset:1024
    s_waitcnt vmcnt(0)
    ds_read_b128 a[96:99], v214 offset:20480
    ds_read_b64_tr_b16 a[104:105], v218 offset:20480
    ds_read_b64_tr_b16 a[106:107], v219 offset:20480
    ds_read_b128 a[100:103], v214 offset:24576
    ds_read_b64_tr_b16 a[108:109], v218 offset:22528
    ds_read_b64_tr_b16 a[110:111], v219 offset:22528
    ds_write_b128 v186, v[56:59] offset:4096
    s_waitcnt lgkmcnt(9)
    ds_read_b128 a[112:115], v215 offset:20480
    ds_read_b64_tr_b16 a[120:121], v218 offset:20736
    ds_read_b64_tr_b16 a[122:123], v219 offset:20736
    ds_read_b128 a[116:119], v215 offset:24576
    ds_read_b64_tr_b16 a[124:125], v218 offset:22784
    ds_read_b64_tr_b16 a[126:127], v219 offset:22784
    ds_write_b128 v186, v[60:63] offset:5120
    s_waitcnt lgkmcnt(9)
    ds_read_b128 a[128:131], v216 offset:20480
    ds_read_b64_tr_b16 a[136:137], v218 offset:24576
    ds_read_b64_tr_b16 a[138:139], v219 offset:24576
    ds_read_b128 a[132:135], v216 offset:24576
    ds_read_b64_tr_b16 a[140:141], v218 offset:26624
    ds_read_b64_tr_b16 a[142:143], v219 offset:26624
    ds_write_b128 v186, v[88:91] offset:8192
    s_waitcnt lgkmcnt(9)
    ds_read_b128 a[144:147], v217 offset:20480
    ds_read_b64_tr_b16 a[152:153], v218 offset:24832
    ds_read_b64_tr_b16 a[154:155], v219 offset:24832
    ds_read_b128 a[148:151], v217 offset:24576
    ds_read_b64_tr_b16 a[156:157], v218 offset:26880
    ds_read_b64_tr_b16 a[158:159], v219 offset:26880
    ds_write_b128 v186, v[92:95] offset:9216
    s_waitcnt lgkmcnt(0)
    s_barrier
    ds_read_b128 v[120:123], v187 offset:2048
    ds_read_b128 v[124:127], v187 offset:3072
    ds_read_b128 v[136:139], v187 offset:6144
    ds_read_b128 v[140:143], v187 offset:7168
    ds_read_b128 v[152:155], v187 offset:10240
    ds_read_b128 v[156:159], v187 offset:11264
    ds_read_b128 v[112:115], v187 offset:0
    ds_read_b128 v[116:119], v187 offset:1024
    ds_read_b128 v[128:131], v187 offset:4096
    ds_read_b128 v[132:135], v187 offset:5120
    ds_read_b128 v[144:147], v187 offset:8192
    ds_read_b128 v[148:151], v187 offset:9216
    s_add_u32 m0, s96, 24576
    s_add_u32 s68, s78, 0
    buffer_load_dwordx4 v210, s[24:27], s68 offen offset:0 lds
    buffer_load_dwordx4 v211, s[24:27], s68 offen offset:1024 lds
    s_lshl_b32 s60, s2, 2
    s_add_u32 s60, s60, s56
    s_lshl_b32 s60, s60, 12
    s_add_u32 s60, s60, 16777216
    s_xor_b32 s97, s60, 16384
    v_mov_b32 v43, s100
    v_mov_b32 v47, s100
    v_mov_b32 v59, s100
    v_mov_b32 v63, s100
    s_waitcnt lgkmcnt(11)
    v_pk_add_f32 v[32:33], v[32:33], v[120:121]
    v_pk_add_f32 v[34:35], v[34:35], v[122:123]
    s_waitcnt lgkmcnt(10)
    v_pk_add_f32 v[36:37], v[36:37], v[124:125]
    v_pk_add_f32 v[38:39], v[38:39], v[126:127]
    s_waitcnt lgkmcnt(9)
    v_pk_add_f32 v[64:65], v[64:65], v[136:137]
    v_pk_add_f32 v[66:67], v[66:67], v[138:139]
    s_waitcnt lgkmcnt(8)
    v_pk_add_f32 v[68:69], v[68:69], v[140:141]
    v_pk_add_f32 v[70:71], v[70:71], v[142:143]
    s_waitcnt lgkmcnt(7)
    v_pk_add_f32 v[96:97], v[96:97], v[152:153]
    v_pk_add_f32 v[98:99], v[98:99], v[154:155]
    s_waitcnt lgkmcnt(6)
    v_pk_add_f32 v[100:101], v[100:101], v[156:157]
    v_pk_add_f32 v[102:103], v[102:103], v[158:159]
    v_cvt_pk_bf16_f32 v40, v32, v33
    v_cvt_pk_bf16_f32 v41, v34, v35
    v_cvt_pk_bf16_f32 v42, v36, v37
    buffer_store_dwordx4 v[40:43], v2, s[16:19], s60 offen offset:0 sc1
    v_cvt_pk_bf16_f32 v44, v38, v39
    v_cvt_pk_bf16_f32 v45, v64, v65
    v_cvt_pk_bf16_f32 v46, v66, v67
    buffer_store_dwordx4 v[44:47], v2, s[16:19], s60 offen offset:1024 sc1
    v_cvt_pk_bf16_f32 v56, v68, v69
    v_cvt_pk_bf16_f32 v57, v70, v71
    v_cvt_pk_bf16_f32 v58, v96, v97
    buffer_store_dwordx4 v[56:59], v2, s[16:19], s60 offen offset:2048 sc1
    v_cvt_pk_bf16_f32 v60, v98, v99
    v_cvt_pk_bf16_f32 v61, v100, v101
    v_cvt_pk_bf16_f32 v62, v102, v103
    buffer_store_dwordx4 v[60:63], v2, s[16:19], s60 offen offset:3072 sc1
    s_waitcnt lgkmcnt(5)
    v_pk_add_f32 v[16:17], v[16:17], v[112:113]
    v_pk_add_f32 v[18:19], v[18:19], v[114:115]
    s_waitcnt lgkmcnt(4)
    v_pk_add_f32 v[20:21], v[20:21], v[116:117]
    v_pk_add_f32 v[22:23], v[22:23], v[118:119]
    s_waitcnt lgkmcnt(3)
    v_pk_add_f32 v[48:49], v[48:49], v[128:129]
    v_pk_add_f32 v[50:51], v[50:51], v[130:131]
    s_waitcnt lgkmcnt(2)
    v_pk_add_f32 v[52:53], v[52:53], v[132:133]
    v_pk_add_f32 v[54:55], v[54:55], v[134:135]
    s_waitcnt lgkmcnt(1)
    v_pk_add_f32 v[80:81], v[80:81], v[144:145]
    v_pk_add_f32 v[82:83], v[82:83], v[146:147]
    s_waitcnt lgkmcnt(0)
    v_pk_add_f32 v[84:85], v[84:85], v[148:149]
    v_pk_add_f32 v[86:87], v[86:87], v[150:151]
    s_barrier
    s_mov_b32 s80, 3184710632
    v_mov_b32 v188, 3222493025
    v_and_b32 v5, 0xffff0000, v190
    v_lshlrev_b32 v4, 16, v190
    v_and_b32 v7, 0xffff0000, v191
    v_lshlrev_b32 v6, 16, v191
    v_and_b32 v9, 0xffff0000, v192
    v_lshlrev_b32 v8, 16, v192
    buffer_load_dwordx4 v212, s[24:27], s68 offen offset:2048 lds
    v_and_b32 v11, 0xffff0000, v193
    v_lshlrev_b32 v10, 16, v193
    v_and_b32 v13, 0xffff0000, v194
    v_lshlrev_b32 v12, 16, v194
    v_and_b32 v15, 0xffff0000, v195
    v_lshlrev_b32 v14, 16, v195
    v_and_b32 v205, 0xffff0000, v196
    v_lshlrev_b32 v204, 16, v196
    buffer_load_dwordx4 v213, s[24:27], s68 offen offset:3072 lds
    s_add_u32 m0, s96, 28672
    s_add_u32 s68, s78, 32768
    v_and_b32 v207, 0xffff0000, v197
    v_lshlrev_b32 v206, 16, v197
    v_and_b32 v209, 0xffff0000, v198
    v_lshlrev_b32 v208, 16, v198
    v_and_b32 v249, 0xffff0000, v199
    v_lshlrev_b32 v248, 16, v199
    v_and_b32 v251, 0xffff0000, v200
    v_lshlrev_b32 v250, 16, v200
    v_and_b32 v253, 0xffff0000, v201
    buffer_load_dwordx4 v210, s[24:27], s68 offen offset:0 lds
    v_lshlrev_b32 v252, 16, v201
    v_pk_mul_f32 v[24:25], v[4:5], v[4:5]
    v_pk_mul_f32 v[26:27], v[6:7], v[6:7]
    v_pk_mul_f32 v[28:29], v[8:9], v[8:9]
    v_pk_mul_f32 v[30:31], v[10:11], v[10:11]
    v_pk_fma_f32 v[24:25], v[24:25], s[80:81], v[188:189] op_sel_hi:[1,0,0]
    v_pk_fma_f32 v[26:27], v[26:27], s[80:81], v[188:189] op_sel_hi:[1,0,0]
    v_pk_fma_f32 v[28:29], v[28:29], s[80:81], v[188:189] op_sel_hi:[1,0,0]
    buffer_load_dwordx4 v211, s[24:27], s68 offen offset:1024 lds
    v_pk_fma_f32 v[30:31], v[30:31], s[80:81], v[188:189] op_sel_hi:[1,0,0]
    v_pk_mul_f32 v[24:25], v[24:25], v[4:5]
    v_pk_mul_f32 v[26:27], v[26:27], v[6:7]
    v_pk_mul_f32 v[28:29], v[28:29], v[8:9]
    v_pk_mul_f32 v[30:31], v[30:31], v[10:11]
    v_exp_f32 v24, v24
    v_exp_f32 v26, v26
    v_exp_f32 v28, v28
    v_exp_f32 v30, v30
    buffer_load_dwordx4 v212, s[24:27], s68 offen offset:2048 lds
    v_exp_f32 v25, v25
    v_exp_f32 v27, v27
    v_exp_f32 v29, v29
    v_exp_f32 v31, v31
    v_pk_add_f32 v[24:25], v[24:25], 1.0 op_sel_hi:[1,0]
    v_pk_add_f32 v[26:27], v[26:27], 1.0 op_sel_hi:[1,0]
    v_pk_add_f32 v[28:29], v[28:29], 1.0 op_sel_hi:[1,0]
    v_pk_add_f32 v[30:31], v[30:31], 1.0 op_sel_hi:[1,0]
    buffer_load_dwordx4 v213, s[24:27], s68 offen offset:3072 lds
    s_add_u32 m0, s96, 32768
    s_add_u32 s68, s79, 8192
    v_rcp_f32 v24, v24
    v_rcp_f32 v26, v26
    v_rcp_f32 v28, v28
    v_rcp_f32 v30, v30
    v_rcp_f32 v25, v25
    v_rcp_f32 v27, v27
    v_rcp_f32 v29, v29
    v_rcp_f32 v31, v31
    v_pk_mul_f32 v[4:5], v[24:25], v[4:5]
    buffer_load_dwordx4 v2, s[16:19], s68 offen offset:0 sc1 lds
    v_pk_mul_f32 v[6:7], v[26:27], v[6:7]
    v_pk_mul_f32 v[8:9], v[28:29], v[8:9]
    v_pk_mul_f32 v[10:11], v[30:31], v[10:11]
    v_pk_mul_f32 v[24:25], v[12:13], v[12:13]
    v_pk_mul_f32 v[26:27], v[14:15], v[14:15]
    v_pk_mul_f32 v[28:29], v[204:205], v[204:205]
    v_pk_mul_f32 v[30:31], v[206:207], v[206:207]
    v_pk_fma_f32 v[24:25], v[24:25], s[80:81], v[188:189] op_sel_hi:[1,0,0]
    buffer_load_dwordx4 v2, s[16:19], s68 offen offset:1024 sc1 lds
    v_pk_fma_f32 v[26:27], v[26:27], s[80:81], v[188:189] op_sel_hi:[1,0,0]
    v_pk_fma_f32 v[28:29], v[28:29], s[80:81], v[188:189] op_sel_hi:[1,0,0]
    v_pk_fma_f32 v[30:31], v[30:31], s[80:81], v[188:189] op_sel_hi:[1,0,0]
    v_pk_mul_f32 v[24:25], v[24:25], v[12:13]
    v_pk_mul_f32 v[26:27], v[26:27], v[14:15]
    v_pk_mul_f32 v[28:29], v[28:29], v[204:205]
    v_pk_mul_f32 v[30:31], v[30:31], v[206:207]
    v_exp_f32 v24, v24
    buffer_load_dwordx4 v2, s[16:19], s68 offen offset:2048 sc1 lds
    v_exp_f32 v26, v26
    v_exp_f32 v28, v28
    v_exp_f32 v30, v30
    v_exp_f32 v25, v25
    v_exp_f32 v27, v27
    v_exp_f32 v29, v29
    v_exp_f32 v31, v31
    v_pk_add_f32 v[24:25], v[24:25], 1.0 op_sel_hi:[1,0]
    v_pk_add_f32 v[26:27], v[26:27], 1.0 op_sel_hi:[1,0]
    buffer_load_dwordx4 v2, s[16:19], s68 offen offset:3072 sc1 lds
    s_add_u32 m0, s96, 36864
    s_add_u32 s68, s79, 12288
    v_pk_add_f32 v[28:29], v[28:29], 1.0 op_sel_hi:[1,0]
    v_pk_add_f32 v[30:31], v[30:31], 1.0 op_sel_hi:[1,0]
    v_rcp_f32 v24, v24
    v_rcp_f32 v26, v26
    v_rcp_f32 v28, v28
    v_rcp_f32 v30, v30
    v_rcp_f32 v25, v25
    v_rcp_f32 v27, v27
    buffer_load_dwordx4 v2, s[16:19], s68 offen offset:0 sc1 lds
    v_rcp_f32 v29, v29
    v_rcp_f32 v31, v31
    v_pk_mul_f32 v[12:13], v[24:25], v[12:13]
    v_pk_mul_f32 v[14:15], v[26:27], v[14:15]
    v_pk_mul_f32 v[204:205], v[28:29], v[204:205]
    v_pk_mul_f32 v[206:207], v[30:31], v[206:207]
    v_pk_mul_f32 v[24:25], v[208:209], v[208:209]
    v_pk_mul_f32 v[26:27], v[248:249], v[248:249]
    v_pk_mul_f32 v[28:29], v[250:251], v[250:251]
    buffer_load_dwordx4 v2, s[16:19], s68 offen offset:1024 sc1 lds
    v_pk_mul_f32 v[30:31], v[252:253], v[252:253]
    v_pk_fma_f32 v[24:25], v[24:25], s[80:81], v[188:189] op_sel_hi:[1,0,0]
    v_pk_fma_f32 v[26:27], v[26:27], s[80:81], v[188:189] op_sel_hi:[1,0,0]
    v_pk_fma_f32 v[28:29], v[28:29], s[80:81], v[188:189] op_sel_hi:[1,0,0]
    v_pk_fma_f32 v[30:31], v[30:31], s[80:81], v[188:189] op_sel_hi:[1,0,0]
    v_pk_mul_f32 v[24:25], v[24:25], v[208:209]
    v_pk_mul_f32 v[26:27], v[26:27], v[248:249]
    v_pk_mul_f32 v[28:29], v[28:29], v[250:251]
    buffer_load_dwordx4 v2, s[16:19], s68 offen offset:2048 sc1 lds
    v_pk_mul_f32 v[30:31], v[30:31], v[252:253]
    v_exp_f32 v24, v24
    v_exp_f32 v26, v26
    v_exp_f32 v28, v28
    v_exp_f32 v30, v30
    v_exp_f32 v25, v25
    v_exp_f32 v27, v27
    v_exp_f32 v29, v29
    v_exp_f32 v31, v31
    buffer_load_dwordx4 v2, s[16:19], s68 offen offset:3072 sc1 lds
    v_pk_add_f32 v[24:25], v[24:25], 1.0 op_sel_hi:[1,0]
    v_pk_add_f32 v[26:27], v[26:27], 1.0 op_sel_hi:[1,0]
    v_pk_add_f32 v[28:29], v[28:29], 1.0 op_sel_hi:[1,0]
    v_pk_add_f32 v[30:31], v[30:31], 1.0 op_sel_hi:[1,0]
    v_rcp_f32 v24, v24
    v_rcp_f32 v26, v26
    v_rcp_f32 v28, v28
    v_rcp_f32 v30, v30
    s_add_u32 m0, s96, 4096
    s_add_u32 s68, s78, 128
    v_rcp_f32 v25, v25
    v_rcp_f32 v27, v27
    v_rcp_f32 v29, v29
    v_rcp_f32 v31, v31
    v_pk_mul_f32 v[208:209], v[24:25], v[208:209]
    v_pk_mul_f32 v[248:249], v[26:27], v[248:249]
    v_pk_mul_f32 v[250:251], v[28:29], v[250:251]
    v_pk_mul_f32 v[252:253], v[30:31], v[252:253]
    buffer_load_dwordx4 v210, s[20:23], s68 offen offset:0 lds
    buffer_load_dwordx4 v[72:75], v2, s[16:19], s97 offen offset:0 sc1
    buffer_load_dwordx4 v[76:79], v2, s[16:19], s97 offen offset:1024 sc1
    buffer_load_dwordx4 v[88:91], v2, s[16:19], s97 offen offset:2048 sc1
    buffer_load_dwordx4 v[92:95], v2, s[16:19], s97 offen offset:3072 sc1
    v_mfma_f32_32x32x16_bf16 v[112:127], a[96:99], a[104:107], 0
    v_lshrrev_b32 v64, 4, v1
    v_and_b32 v65, 15, v1
    v_lshlrev_b32 v66, 10, v64
    v_lshl_add_u32 v66, v65, 3, v66
    v_mfma_f32_32x32x16_bf16 v[144:159], a[100:103], a[104:107], 0
    v_lshlrev_b32 v67, 2, v64
    v_lshlrev_b32 v68, 3, v65
    v_lshlrev_b32 v184, 1, v66
    buffer_load_dwordx4 v211, s[20:23], s68 offen offset:1024 lds
    s_lshl_b32 s75, s59, 6
    v_mfma_f32_32x32x16_bf16 v[160:175], a[100:103], a[108:111], 0
    s_lshl_b32 s60, s56, 4
    s_add_u32 s75, s75, s60
    s_lshl_b32 s76, s75, 10
    s_lshl_b32 s60, s58, 7
    s_add_u32 s76, s76, s60
    v_mfma_f32_32x32x16_bf16 v[128:143], a[96:99], a[108:111], 0
    v_add_u32 v68, s60, v68
    buffer_load_dwordx4 v212, s[20:23], s68 offen offset:2048 lds
    s_lshl_b32 s60, s59, 12
    s_lshl_b32 s61, s56, 10
    s_add_u32 s61, s61, s60
    v_mfma_f32_32x32x16_bf16 v[112:127], a[112:115], a[120:123], v[112:127]
    s_add_u32 s61, s61, 14811136
    v_mov_b32 v222, v3
    s_sub_u32 s61, s61, 0
    v_lshl_add_u32 v223, v1, 7, s61
    buffer_load_dwordx4 v213, s[20:23], s68 offen offset:3072 lds
    s_add_u32 m0, s96, 8192
    s_add_u32 s68, s78, 32896
    v_mfma_f32_32x32x16_bf16 v[144:159], a[116:119], a[120:123], v[144:159]
    s_mov_b32 vcc_lo, 255
    s_mov_b32 vcc_hi, 0
    v_cndmask_b32 v222, v222, v223, vcc
    s_cmp_eq_u32 s56, 3
    s_cselect_b64 vcc, -1, 0
    v_cndmask_b32 v185, v2, v3, vcc
    v_mfma_f32_32x32x16_bf16 v[160:175], a[116:119], a[124:127], v[160:175]
    s_mul_i32 s74, s59, 90112
    s_mul_i32 s60, s56, 11264
    buffer_load_dwordx4 v210, s[20:23], s68 offen offset:0 lds
    s_add_u32 s74, s74, s60
    s_add_u32 s74, s74, 7340032
    v_mfma_f32_32x32x16_bf16 v[128:143], a[112:115], a[124:127], v[128:143]
    s_add_u32 s60, s96, 4096
    v_and_b32 v176, 31, v1
    v_lshlrev_b32 v176, 8, v176
    v_add_u32 v176, s60, v176
    v_lshrrev_b32 v177, 5, v1
    buffer_load_dwordx4 v211, s[20:23], s68 offen offset:1024 lds
    v_mfma_f32_32x32x16_bf16 v[112:127], a[128:131], a[136:139], v[112:127]
    v_and_b32 v178, 7, v1
    v_xor_b32 v177, v177, v178
    v_lshlrev_b32 v177, 4, v177
    v_xor_b32 v180, 0, v177
    v_mfma_f32_32x32x16_bf16 v[144:159], a[132:135], a[136:139], v[144:159]
    v_add_u32 v180, v180, v176
    v_xor_b32 v181, 32, v177
    v_add_u32 v181, v181, v176
    buffer_load_dwordx4 v212, s[20:23], s68 offen offset:2048 lds
    v_xor_b32 v182, 64, v177
    v_mfma_f32_32x32x16_bf16 v[160:175], a[132:135], a[140:143], v[160:175]
    v_add_u32 v182, v182, v176
    v_xor_b32 v183, 96, v177
    v_add_u32 v183, v183, v176
    v_xor_b32 v65, v65, v64
    v_lshlrev_b32 v65, 4, v65
    v_mfma_f32_32x32x16_bf16 v[128:143], a[128:131], a[140:143], v[128:143]
    v_lshlrev_b32 v64, 8, v64
    buffer_load_dwordx4 v213, s[20:23], s68 offen offset:3072 lds
    s_add_u32 m0, s96, 12288
    s_add_u32 s68, s79, 16384
    s_lshl_b32 s60, s56, 12
    s_add_u32 s60, s60, 4096
    v_add_u32 v64, s60, v64
    v_mfma_f32_32x32x16_bf16 v[112:127], a[144:147], a[152:155], v[112:127]
    v_add_u32 v230, v64, v65
    v_xor_b32 v65, 64, v65
    v_add_u32 v231, v64, v65
    v_add_u32 v232, 81920, v230
    buffer_load_dwordx4 v2, s[16:19], s68 offen offset:0 sc1 lds
    v_mfma_f32_32x32x16_bf16 v[144:159], a[148:151], a[152:155], v[144:159]
    v_add_u32 v233, 81920, v231
    s_lshr_b32 s101, s62, 1
    s_lshl_b32 s101, s101, 3
    s_add_u32 s101, s101, s58
    s_lshl_b32 s101, s101, 1
    v_mfma_f32_32x32x16_bf16 v[160:175], a[148:151], a[156:159], v[160:175]
    s_add_u32 s101, s101, s81
    s_lshl_b32 s101, s101, 1
    buffer_load_dwordx4 v2, s[16:19], s68 offen offset:1024 sc1 lds
    s_add_u32 s101, s101, s89
    s_lshl_b32 s101, s101, 7
    v_mfma_f32_32x32x16_bf16 v[128:143], a[144:147], a[156:159], v[128:143]
    s_add_u32 s101, s101, 14811136
    s_add_u32 s63, s86, 7340032
    v_lshlrev_b32 v202, 16, v202
    v_sub_f32 v178, 1.0, v241
    v_mul_f32 v179, v178, v202
    buffer_load_dwordx4 v2, s[16:19], s68 offen offset:2048 sc1 lds
    s_add_u32 s60, s76, 0
    buffer_load_dwordx2 v[186:187], v66, s[4:7], s60 offen
    s_add_u32 s60, s76, 4096
    buffer_load_dwordx2 v[188:189], v66, s[4:7], s60 offen
    s_add_u32 s60, s76, 8192
    buffer_load_dwordx2 v[190:191], v66, s[4:7], s60 offen
    s_add_u32 s60, s76, 12288
    buffer_load_dwordx2 v[192:193], v66, s[4:7], s60 offen
    s_lshl_b32 s60, s75, 2
    s_add_u32 s60, s60, 16384
    buffer_load_dword v194, v67, s[16:19], s60 offen offset:0 sc1
    buffer_load_dword v195, v67, s[16:19], s60 offen offset:16 sc1
    buffer_load_dword v196, v67, s[16:19], s60 offen offset:32 sc1
    buffer_load_dword v197, v67, s[16:19], s60 offen offset:48 sc1
    global_load_dwordx2 v[198:199], v68, s[42:43]
    s_waitcnt vmcnt(19)
    s_mov_b32 s99, 0
.Lxp_23:
    v_xor_b32 v32, s100, v75
    v_xor_b32 v33, s100, v79
    v_xor_b32 v34, s100, v91
    v_xor_b32 v35, s100, v95
    v_or3_b32 v32, v32, v33, v34
    v_or_b32 v32, v32, v35
    v_cmp_ne_u32 vcc, 0, v32
    s_nop 0
    s_cmp_eq_u64 vcc, 0
    s_cbranch_scc1 .Lxd_24
    buffer_load_dwordx4 v[72:75], v2, s[16:19], s97 offen offset:0 sc1
    buffer_load_dwordx4 v[76:79], v2, s[16:19], s97 offen offset:1024 sc1
    buffer_load_dwordx4 v[88:91], v2, s[16:19], s97 offen offset:2048 sc1
    buffer_load_dwordx4 v[92:95], v2, s[16:19], s97 offen offset:3072 sc1
    s_waitcnt vmcnt(0)
    s_add_u32 s99, s99, 1
    s_cmp_lt_u32 s99, 200000
    s_cbranch_scc1 .Lxp_23
.Lxd_24:
    v_and_b32 v33, 0xffff0000, v72
    v_lshlrev_b32 v32, 16, v72
    v_and_b32 v35, 0xffff0000, v73
    v_lshlrev_b32 v34, 16, v73
    v_and_b32 v37, 0xffff0000, v74
    v_lshlrev_b32 v36, 16, v74
    v_and_b32 v39, 0xffff0000, v76
    v_lshlrev_b32 v38, 16, v76
    v_pk_add_f32 v[16:17], v[16:17], v[32:33]
    v_pk_add_f32 v[18:19], v[18:19], v[34:35]
    v_pk_add_f32 v[20:21], v[20:21], v[36:37]
    v_pk_add_f32 v[22:23], v[22:23], v[38:39]
    v_pk_fma_f32 v[16:17], v[16:17], v[178:179], v[178:179] op_sel:[0,0,1] op_sel_hi:[1,0,1]
    v_pk_fma_f32 v[18:19], v[18:19], v[178:179], v[178:179] op_sel:[0,0,1] op_sel_hi:[1,0,1]
    v_pk_fma_f32 v[20:21], v[20:21], v[178:179], v[178:179] op_sel:[0,0,1] op_sel_hi:[1,0,1]
    v_pk_fma_f32 v[22:23], v[22:23], v[178:179], v[178:179] op_sel:[0,0,1] op_sel_hi:[1,0,1]
    v_pk_mul_f32 v[16:17], v[16:17], v[4:5]
    v_pk_mul_f32 v[18:19], v[18:19], v[6:7]
    v_pk_mul_f32 v[20:21], v[20:21], v[8:9]
    v_pk_mul_f32 v[22:23], v[22:23], v[10:11]
    v_cvt_pk_bf16_f32 v24, v16, v17
    v_cvt_pk_bf16_f32 v25, v18, v19
    v_cvt_pk_bf16_f32 v26, v20, v21
    v_cvt_pk_bf16_f32 v27, v22, v23
    buffer_store_dwordx4 v[24:27], v2, s[16:19], s63 offen sc1
    v_and_b32 v33, 0xffff0000, v77
    v_lshlrev_b32 v32, 16, v77
    v_and_b32 v35, 0xffff0000, v78
    v_lshlrev_b32 v34, 16, v78
    v_and_b32 v37, 0xffff0000, v88
    v_lshlrev_b32 v36, 16, v88
    v_and_b32 v39, 0xffff0000, v89
    v_lshlrev_b32 v38, 16, v89
    v_pk_add_f32 v[48:49], v[48:49], v[32:33]
    v_pk_add_f32 v[50:51], v[50:51], v[34:35]
    v_pk_add_f32 v[52:53], v[52:53], v[36:37]
    v_pk_add_f32 v[54:55], v[54:55], v[38:39]
    v_pk_fma_f32 v[48:49], v[48:49], v[178:179], v[178:179] op_sel:[0,0,1] op_sel_hi:[1,0,1]
    v_pk_fma_f32 v[50:51], v[50:51], v[178:179], v[178:179] op_sel:[0,0,1] op_sel_hi:[1,0,1]
    v_pk_fma_f32 v[52:53], v[52:53], v[178:179], v[178:179] op_sel:[0,0,1] op_sel_hi:[1,0,1]
    v_pk_fma_f32 v[54:55], v[54:55], v[178:179], v[178:179] op_sel:[0,0,1] op_sel_hi:[1,0,1]
    v_pk_mul_f32 v[48:49], v[48:49], v[12:13]
    v_pk_mul_f32 v[50:51], v[50:51], v[14:15]
    v_pk_mul_f32 v[52:53], v[52:53], v[204:205]
    v_pk_mul_f32 v[54:55], v[54:55], v[206:207]
    v_cvt_pk_bf16_f32 v28, v48, v49
    v_cvt_pk_bf16_f32 v29, v50, v51
    v_cvt_pk_bf16_f32 v30, v52, v53
    v_cvt_pk_bf16_f32 v31, v54, v55
    buffer_store_dwordx4 v[28:31], v227, s[16:19], s63 offen offset:2048 sc1
    s_add_u32 s63, s63, 4096
    v_and_b32 v33, 0xffff0000, v90
    v_lshlrev_b32 v32, 16, v90
    v_and_b32 v35, 0xffff0000, v92
    v_lshlrev_b32 v34, 16, v92
    v_and_b32 v37, 0xffff0000, v93
    v_lshlrev_b32 v36, 16, v93
    v_and_b32 v39, 0xffff0000, v94
    v_lshlrev_b32 v38, 16, v94
    v_pk_add_f32 v[80:81], v[80:81], v[32:33]
    v_pk_add_f32 v[82:83], v[82:83], v[34:35]
    v_pk_add_f32 v[84:85], v[84:85], v[36:37]
    v_pk_add_f32 v[86:87], v[86:87], v[38:39]
    v_pk_fma_f32 v[80:81], v[80:81], v[178:179], v[178:179] op_sel:[0,0,1] op_sel_hi:[1,0,1]
    v_pk_fma_f32 v[82:83], v[82:83], v[178:179], v[178:179] op_sel:[0,0,1] op_sel_hi:[1,0,1]
    v_pk_fma_f32 v[84:85], v[84:85], v[178:179], v[178:179] op_sel:[0,0,1] op_sel_hi:[1,0,1]
    v_pk_fma_f32 v[86:87], v[86:87], v[178:179], v[178:179] op_sel:[0,0,1] op_sel_hi:[1,0,1]
    v_pk_mul_f32 v[80:81], v[80:81], v[208:209]
    v_pk_mul_f32 v[82:83], v[82:83], v[248:249]
    v_pk_mul_f32 v[84:85], v[84:85], v[250:251]
    v_pk_mul_f32 v[86:87], v[86:87], v[252:253]
    v_cvt_pk_bf16_f32 v104, v80, v81
    v_cvt_pk_bf16_f32 v105, v82, v83
    v_cvt_pk_bf16_f32 v106, v84, v85
    v_cvt_pk_bf16_f32 v107, v86, v87
    buffer_store_dwordx4 v[104:107], v203, s[16:19], s63 offen sc1
    ds_read_b128 a[160:163], v214 offset:20480
    ds_read_b64_tr_b16 a[168:169], v218 offset:20480
    ds_read_b64_tr_b16 a[170:171], v219 offset:20480
    ds_read_b128 a[164:167], v214 offset:24576
    ds_read_b64_tr_b16 a[172:173], v218 offset:22528
    ds_read_b64_tr_b16 a[174:175], v219 offset:22528
    buffer_load_dwordx4 v2, s[16:19], s68 offen offset:3072 sc1 lds
    s_add_u32 m0, s96, 16384
    s_add_u32 s68, s79, 20480
    ds_read_b128 a[176:179], v215 offset:20480
    ds_read_b64_tr_b16 a[184:185], v218 offset:20736
    ds_read_b64_tr_b16 a[186:187], v219 offset:20736
    ds_read_b128 a[180:183], v215 offset:24576
    ds_read_b64_tr_b16 a[188:189], v218 offset:22784
    ds_read_b64_tr_b16 a[190:191], v219 offset:22784
    buffer_load_dwordx4 v2, s[16:19], s68 offen offset:0 sc1 lds
    s_waitcnt lgkmcnt(9)
    ds_read_b128 a[192:195], v216 offset:20480
    ds_read_b64_tr_b16 a[200:201], v218 offset:24576
    ds_read_b64_tr_b16 a[202:203], v219 offset:24576
    ds_read_b128 a[196:199], v216 offset:24576
    ds_read_b64_tr_b16 a[204:205], v218 offset:26624
    ds_read_b64_tr_b16 a[206:207], v219 offset:26624
    buffer_load_dwordx4 v2, s[16:19], s68 offen offset:1024 sc1 lds
    s_waitcnt lgkmcnt(9)
    ds_read_b128 a[208:211], v217 offset:20480
    ds_read_b64_tr_b16 a[216:217], v218 offset:24832
    ds_read_b64_tr_b16 a[218:219], v219 offset:24832
    ds_read_b128 a[212:215], v217 offset:24576
    ds_read_b64_tr_b16 a[220:221], v218 offset:26880
    ds_read_b64_tr_b16 a[222:223], v219 offset:26880
    buffer_load_dwordx4 v2, s[16:19], s68 offen offset:2048 sc1 lds
    v_mfma_f32_32x32x16_bf16 v[112:127], a[160:163], a[168:171], v[112:127]
    v_mfma_f32_32x32x16_bf16 v[144:159], a[164:167], a[168:171], v[144:159]
    buffer_load_dwordx4 v2, s[16:19], s68 offen offset:3072 sc1 lds
    v_mfma_f32_32x32x16_bf16 v[160:175], a[164:167], a[172:175], v[160:175]
    s_waitcnt lgkmcnt(0)
    v_mfma_f32_32x32x16_bf16 v[128:143], a[160:163], a[172:175], v[128:143]
    v_mfma_f32_32x32x16_bf16 v[112:127], a[176:179], a[184:187], v[112:127]
    s_add_u32 m0, s96, 24576
    s_add_u32 s68, s78, 128
    v_mfma_f32_32x32x16_bf16 v[144:159], a[180:183], a[184:187], v[144:159]
    buffer_load_dwordx4 v210, s[24:27], s68 offen offset:0 lds
    v_mfma_f32_32x32x16_bf16 v[160:175], a[180:183], a[188:191], v[160:175]
    v_mfma_f32_32x32x16_bf16 v[128:143], a[176:179], a[188:191], v[128:143]
    buffer_load_dwordx4 v211, s[24:27], s68 offen offset:1024 lds
    v_mfma_f32_32x32x16_bf16 v[112:127], a[192:195], a[200:203], v[112:127]
    buffer_load_dwordx4 v212, s[24:27], s68 offen offset:2048 lds
    v_mfma_f32_32x32x16_bf16 v[144:159], a[196:199], a[200:203], v[144:159]
    v_mfma_f32_32x32x16_bf16 v[160:175], a[196:199], a[204:207], v[160:175]
    buffer_load_dwordx4 v213, s[24:27], s68 offen offset:3072 lds
    s_add_u32 m0, s96, 28672
    s_add_u32 s68, s78, 32896
    v_mfma_f32_32x32x16_bf16 v[128:143], a[192:195], a[204:207], v[128:143]
    buffer_load_dwordx4 v210, s[24:27], s68 offen offset:0 lds
    v_mfma_f32_32x32x16_bf16 v[112:127], a[208:211], a[216:219], v[112:127]
    v_mfma_f32_32x32x16_bf16 v[144:159], a[212:215], a[216:219], v[144:159]
    buffer_load_dwordx4 v211, s[24:27], s68 offen offset:1024 lds
    v_mfma_f32_32x32x16_bf16 v[160:175], a[212:215], a[220:223], v[160:175]
    buffer_load_dwordx4 v212, s[24:27], s68 offen offset:2048 lds
    v_mfma_f32_32x32x16_bf16 v[128:143], a[208:211], a[220:223], v[128:143]
    buffer_load_dwordx4 v213, s[24:27], s68 offen offset:3072 lds
    s_add_u32 m0, s96, 32768
    s_add_u32 s68, s79, 24576
    s_waitcnt vmcnt(8)
    ds_read_b128 a[96:99], v214 offset:0
    ds_read_b64_tr_b16 a[104:105], v218 offset:0
    ds_read_b64_tr_b16 a[106:107], v219 offset:0
    ds_read_b128 a[100:103], v214 offset:4096
    ds_read_b64_tr_b16 a[108:109], v218 offset:2048
    ds_read_b64_tr_b16 a[110:111], v219 offset:2048
    buffer_load_dwordx4 v2, s[16:19], s68 offen offset:0 sc1 lds
    ds_read_b128 a[112:115], v215 offset:0
    ds_read_b64_tr_b16 a[120:121], v218 offset:256
    ds_read_b64_tr_b16 a[122:123], v219 offset:256
    ds_read_b128 a[116:119], v215 offset:4096
    ds_read_b64_tr_b16 a[124:125], v218 offset:2304
    ds_read_b64_tr_b16 a[126:127], v219 offset:2304
    buffer_load_dwordx4 v2, s[16:19], s68 offen offset:1024 sc1 lds
    s_waitcnt lgkmcnt(9)
    ds_read_b128 a[128:131], v216 offset:0
    ds_read_b64_tr_b16 a[136:137], v218 offset:4096
    ds_read_b64_tr_b16 a[138:139], v219 offset:4096
    ds_read_b128 a[132:135], v216 offset:4096
    ds_read_b64_tr_b16 a[140:141], v218 offset:6144
    ds_read_b64_tr_b16 a[142:143], v219 offset:6144
    buffer_load_dwordx4 v2, s[16:19], s68 offen offset:2048 sc1 lds
    s_waitcnt lgkmcnt(9)
    ds_read_b128 a[144:147], v217 offset:0
    ds_read_b64_tr_b16 a[152:153], v218 offset:4352
    ds_read_b64_tr_b16 a[154:155], v219 offset:4352
    ds_read_b128 a[148:151], v217 offset:4096
    ds_read_b64_tr_b16 a[156:157], v218 offset:6400
    ds_read_b64_tr_b16 a[158:159], v219 offset:6400
    buffer_load_dwordx4 v2, s[16:19], s68 offen offset:3072 sc1 lds
    s_add_u32 m0, s96, 36864
    s_add_u32 s68, s79, 28672
    v_mfma_f32_32x32x16_bf16 v[112:127], a[96:99], a[104:107], v[112:127]
    v_mfma_f32_32x32x16_bf16 v[144:159], a[100:103], a[104:107], v[144:159]
    buffer_load_dwordx4 v2, s[16:19], s68 offen offset:0 sc1 lds
    v_mfma_f32_32x32x16_bf16 v[160:175], a[100:103], a[108:111], v[160:175]
    v_mfma_f32_32x32x16_bf16 v[128:143], a[96:99], a[108:111], v[128:143]
    buffer_load_dwordx4 v2, s[16:19], s68 offen offset:1024 sc1 lds
    s_waitcnt lgkmcnt(12)
    v_mfma_f32_32x32x16_bf16 v[112:127], a[112:115], a[120:123], v[112:127]
    v_mfma_f32_32x32x16_bf16 v[144:159], a[116:119], a[120:123], v[144:159]
    buffer_load_dwordx4 v2, s[16:19], s68 offen offset:2048 sc1 lds
    v_mfma_f32_32x32x16_bf16 v[160:175], a[116:119], a[124:127], v[160:175]
    v_mfma_f32_32x32x16_bf16 v[128:143], a[112:115], a[124:127], v[128:143]
    buffer_load_dwordx4 v2, s[16:19], s68 offen offset:3072 sc1 lds
    s_waitcnt lgkmcnt(6)
    v_mfma_f32_32x32x16_bf16 v[112:127], a[128:131], a[136:139], v[112:127]
    s_add_u32 s61, s74, 0
    buffer_load_dwordx4 v[16:19], v2, s[16:19], s61 offen offset:0 sc1
    v_mfma_f32_32x32x16_bf16 v[144:159], a[132:135], a[136:139], v[144:159]
    v_mfma_f32_32x32x16_bf16 v[160:175], a[132:135], a[140:143], v[160:175]
    buffer_load_dwordx4 v[24:27], v2, s[16:19], s61 offen offset:1024 sc1
    v_mfma_f32_32x32x16_bf16 v[128:143], a[128:131], a[140:143], v[128:143]
    s_waitcnt lgkmcnt(0)
    v_mfma_f32_32x32x16_bf16 v[112:127], a[144:147], a[152:155], v[112:127]
    buffer_load_dwordx4 v[32:35], v2, s[16:19], s61 offen offset:2048 sc1
    v_mfma_f32_32x32x16_bf16 v[144:159], a[148:151], a[152:155], v[144:159]
    v_mfma_f32_32x32x16_bf16 v[160:175], a[148:151], a[156:159], v[160:175]
    buffer_load_dwordx4 v[40:43], v2, s[16:19], s61 offen offset:3072 sc1
    v_mfma_f32_32x32x16_bf16 v[128:143], a[144:147], a[156:159], v[128:143]
    s_add_u32 s61, s74, 4096
    buffer_load_dwordx4 v[48:51], v2, s[16:19], s61 offen offset:0 sc1
    s_waitcnt vmcnt(5)
    ds_read_b128 a[160:163], v214 offset:20480
    ds_read_b64_tr_b16 a[168:169], v218 offset:20480
    ds_read_b64_tr_b16 a[170:171], v219 offset:20480
    ds_read_b128 a[164:167], v214 offset:24576
    ds_read_b64_tr_b16 a[172:173], v218 offset:22528
    ds_read_b64_tr_b16 a[174:175], v219 offset:22528
    buffer_load_dwordx4 v[56:59], v2, s[16:19], s61 offen offset:1024 sc1
    ds_read_b128 a[176:179], v215 offset:20480
    ds_read_b64_tr_b16 a[184:185], v218 offset:20736
    ds_read_b64_tr_b16 a[186:187], v219 offset:20736
    ds_read_b128 a[180:183], v215 offset:24576
    ds_read_b64_tr_b16 a[188:189], v218 offset:22784
    ds_read_b64_tr_b16 a[190:191], v219 offset:22784
    buffer_load_dwordx4 v[64:67], v2, s[16:19], s61 offen offset:2048 sc1
    s_waitcnt lgkmcnt(9)
    ds_read_b128 a[192:195], v216 offset:20480
    ds_read_b64_tr_b16 a[200:201], v218 offset:24576
    ds_read_b64_tr_b16 a[202:203], v219 offset:24576
    ds_read_b128 a[196:199], v216 offset:24576
    ds_read_b64_tr_b16 a[204:205], v218 offset:26624
    ds_read_b64_tr_b16 a[206:207], v219 offset:26624
    buffer_load_dwordx4 v[72:75], v2, s[16:19], s61 offen offset:3072 sc1
    s_waitcnt lgkmcnt(9)
    ds_read_b128 a[208:211], v217 offset:20480
    ds_read_b64_tr_b16 a[216:217], v218 offset:24832
    ds_read_b64_tr_b16 a[218:219], v219 offset:24832
    ds_read_b128 a[212:215], v217 offset:24576
    ds_read_b64_tr_b16 a[220:221], v218 offset:26880
    ds_read_b64_tr_b16 a[222:223], v219 offset:26880
    s_add_u32 s61, s74, 8192
    buffer_load_dwordx4 v[80:83], v2, s[16:19], s61 offen offset:0 sc1
    v_mfma_f32_32x32x16_bf16 v[112:127], a[160:163], a[168:171], v[112:127]
    v_mfma_f32_32x32x16_bf16 v[144:159], a[164:167], a[168:171], v[144:159]
    buffer_load_dwordx4 v[88:91], v2, s[16:19], s61 offen offset:1024 sc1
    v_mfma_f32_32x32x16_bf16 v[160:175], a[164:167], a[172:175], v[160:175]
    v_mfma_f32_32x32x16_bf16 v[128:143], a[160:163], a[172:175], v[128:143]
    buffer_load_dwordx4 v[96:99], v185, s[16:19], s61 offen offset:2048 sc1
    s_waitcnt lgkmcnt(12)
    v_mfma_f32_32x32x16_bf16 v[112:127], a[176:179], a[184:187], v[112:127]
    v_mfma_f32_32x32x16_bf16 v[144:159], a[180:183], a[184:187], v[144:159]
    s_add_u32 s61, s74, 45056
    buffer_load_dwordx4 v[20:23], v2, s[16:19], s61 offen offset:0 sc1
    v_mfma_f32_32x32x16_bf16 v[160:175], a[180:183], a[188:191], v[160:175]
    v_mfma_f32_32x32x16_bf16 v[128:143], a[176:179], a[188:191], v[128:143]
    buffer_load_dwordx4 v[28:31], v2, s[16:19], s61 offen offset:1024 sc1
    s_waitcnt lgkmcnt(6)
    v_mfma_f32_32x32x16_bf16 v[112:127], a[192:195], a[200:203], v[112:127]
    v_mfma_f32_32x32x16_bf16 v[144:159], a[196:199], a[200:203], v[144:159]
    buffer_load_dwordx4 v[36:39], v2, s[16:19], s61 offen offset:2048 sc1
    v_mfma_f32_32x32x16_bf16 v[160:175], a[196:199], a[204:207], v[160:175]
    v_mfma_f32_32x32x16_bf16 v[128:143], a[192:195], a[204:207], v[128:143]
    buffer_load_dwordx4 v[44:47], v2, s[16:19], s61 offen offset:3072 sc1
    s_waitcnt lgkmcnt(0)
    v_mfma_f32_32x32x16_bf16 v[112:127], a[208:211], a[216:219], v[112:127]
    v_mfma_f32_32x32x16_bf16 v[144:159], a[212:215], a[216:219], v[144:159]
    s_add_u32 s61, s74, 49152
    buffer_load_dwordx4 v[52:55], v2, s[16:19], s61 offen offset:0 sc1
    v_mfma_f32_32x32x16_bf16 v[160:175], a[212:215], a[220:223], v[160:175]
    v_mfma_f32_32x32x16_bf16 v[128:143], a[208:211], a[220:223], v[128:143]
    buffer_load_dwordx4 v[60:63], v2, s[16:19], s61 offen offset:1024 sc1
    s_nop 5
    v_pk_mul_f32 v[112:113], v[112:113], v[240:241] op_sel_hi:[1,0]
    v_pk_mul_f32 v[114:115], v[114:115], v[240:241] op_sel_hi:[1,0]
    v_pk_mul_f32 v[116:117], v[116:117], v[240:241] op_sel_hi:[1,0]
    v_pk_mul_f32 v[118:119], v[118:119], v[240:241] op_sel_hi:[1,0]
    v_pk_mul_f32 v[120:121], v[120:121], v[240:241] op_sel_hi:[1,0]
    v_pk_mul_f32 v[122:123], v[122:123], v[240:241] op_sel_hi:[1,0]
    v_pk_mul_f32 v[124:125], v[124:125], v[240:241] op_sel_hi:[1,0]
    v_pk_mul_f32 v[126:127], v[126:127], v[240:241] op_sel_hi:[1,0]
    buffer_load_dwordx4 v[68:71], v2, s[16:19], s61 offen offset:2048 sc1
    v_pk_mul_f32 v[144:145], v[144:145], v[240:241] op_sel_hi:[1,0]
    v_pk_mul_f32 v[146:147], v[146:147], v[240:241] op_sel_hi:[1,0]
    v_pk_mul_f32 v[148:149], v[148:149], v[240:241] op_sel_hi:[1,0]
    v_pk_mul_f32 v[150:151], v[150:151], v[240:241] op_sel_hi:[1,0]
    v_pk_mul_f32 v[152:153], v[152:153], v[240:241] op_sel_hi:[1,0]
    v_pk_mul_f32 v[154:155], v[154:155], v[240:241] op_sel_hi:[1,0]
    v_pk_mul_f32 v[156:157], v[156:157], v[240:241] op_sel_hi:[1,0]
    v_pk_mul_f32 v[158:159], v[158:159], v[240:241] op_sel_hi:[1,0]
    buffer_load_dwordx4 v[76:79], v2, s[16:19], s61 offen offset:3072 sc1
    s_waitcnt vmcnt(8)
    s_mov_b32 s99, 0
.Lsp_25:
    v_max3_u32 v178, v16, v24, v32
    v_max3_u32 v178, v178, v40, v48
    v_max3_u32 v178, v178, v56, v64
    v_max3_u32 v178, v178, v72, v80
    v_max3_u32 v178, v178, v88, v96
    v_cmp_eq_u32 vcc, -1, v178
    s_nop 0
    s_cmp_eq_u64 vcc, 0
    s_cbranch_scc1 .Lsd_26
    s_add_u32 s98, s74, 0
    buffer_load_dwordx4 v[16:19], v2, s[16:19], s98 offen offset:0 sc1
    buffer_load_dwordx4 v[24:27], v2, s[16:19], s98 offen offset:1024 sc1
    buffer_load_dwordx4 v[32:35], v2, s[16:19], s98 offen offset:2048 sc1
    buffer_load_dwordx4 v[40:43], v2, s[16:19], s98 offen offset:3072 sc1
    s_add_u32 s98, s74, 4096
    buffer_load_dwordx4 v[48:51], v2, s[16:19], s98 offen offset:0 sc1
    buffer_load_dwordx4 v[56:59], v2, s[16:19], s98 offen offset:1024 sc1
    buffer_load_dwordx4 v[64:67], v2, s[16:19], s98 offen offset:2048 sc1
    buffer_load_dwordx4 v[72:75], v2, s[16:19], s98 offen offset:3072 sc1
    s_add_u32 s98, s74, 8192
    buffer_load_dwordx4 v[80:83], v2, s[16:19], s98 offen offset:0 sc1
    buffer_load_dwordx4 v[88:91], v2, s[16:19], s98 offen offset:1024 sc1
    buffer_load_dwordx4 v[96:99], v185, s[16:19], s98 offen offset:2048 sc1
    s_waitcnt vmcnt(0)
    s_add_u32 s99, s99, 1
    s_cmp_lt_u32 s99, 200000
    s_cbranch_scc1 .Lsp_25
.Lsd_26:
    v_mfma_f32_32x32x16_bf16 v[112:127], a[24:27], v[16:19], v[112:127]
    v_mul_f32 v160, v160, v242
    v_mul_f32 v161, v161, v242
    v_mul_f32 v162, v162, v242
    v_mfma_f32_32x32x16_bf16 v[144:159], a[28:31], v[16:19], v[144:159]
    v_mul_f32 v163, v163, v242
    v_mul_f32 v164, v164, v242
    v_mul_f32 v165, v165, v242
    v_mfma_f32_32x32x16_bf16 v[112:127], a[32:35], v[24:27], v[112:127]
    v_mul_f32 v166, v166, v242
    v_mul_f32 v167, v167, v242
    v_mul_f32 v168, v168, v242
    v_mul_f32 v169, v169, v242
    v_mfma_f32_32x32x16_bf16 v[144:159], a[36:39], v[24:27], v[144:159]
    v_mul_f32 v170, v170, v242
    v_mul_f32 v171, v171, v242
    v_mul_f32 v172, v172, v242
    s_add_u32 s61, s74, 53248
    buffer_load_dwordx4 v[84:87], v2, s[16:19], s61 offen offset:0 sc1
    v_mul_f32 v173, v173, v242
    v_mul_f32 v174, v174, v242
    v_mul_f32 v175, v175, v242
    v_mul_f32 v128, v128, v242
    v_mfma_f32_32x32x16_bf16 v[112:127], a[40:43], v[32:35], v[112:127]
    v_mul_f32 v129, v129, v242
    v_mul_f32 v130, v130, v242
    v_mul_f32 v131, v131, v242
    v_mfma_f32_32x32x16_bf16 v[144:159], a[44:47], v[32:35], v[144:159]
    v_mul_f32 v132, v132, v242
    v_mul_f32 v133, v133, v242
    v_mul_f32 v134, v134, v242
    v_mfma_f32_32x32x16_bf16 v[112:127], a[48:51], v[40:43], v[112:127]
    v_mul_f32 v135, v135, v242
    v_mul_f32 v136, v136, v242
    v_mul_f32 v137, v137, v242
    v_mul_f32 v138, v138, v242
    v_mfma_f32_32x32x16_bf16 v[144:159], a[52:55], v[40:43], v[144:159]
    v_mul_f32 v139, v139, v242
    v_mul_f32 v140, v140, v242
    v_mul_f32 v141, v141, v242
    buffer_load_dwordx4 v[92:95], v2, s[16:19], s61 offen offset:1024 sc1
    v_mul_f32 v142, v142, v242
    v_mul_f32 v143, v143, v242
    v_and_b32 v105, 0xffff0000, v198
    v_mfma_f32_32x32x16_bf16 v[112:127], a[56:59], v[48:51], v[112:127]
    v_lshlrev_b32 v104, 16, v198
    v_and_b32 v107, 0xffff0000, v199
    v_lshlrev_b32 v106, 16, v199
    v_mfma_f32_32x32x16_bf16 v[144:159], a[60:63], v[48:51], v[144:159]
    v_and_b32 v5, 0xffff0000, v186
    v_lshlrev_b32 v4, 16, v186
    v_and_b32 v7, 0xffff0000, v187
    v_mfma_f32_32x32x16_bf16 v[112:127], a[64:67], v[56:59], v[112:127]
    v_lshlrev_b32 v6, 16, v187
    v_mul_f32 v4, v4, v104
    v_mul_f32 v5, v5, v105
    v_mul_f32 v6, v6, v106
    v_mfma_f32_32x32x16_bf16 v[144:159], a[68:71], v[56:59], v[144:159]
    v_mul_f32 v7, v7, v107
    v_mul_f32 v4, v4, v194
    v_mul_f32 v5, v5, v194
    buffer_load_dwordx4 v[100:103], v185, s[16:19], s61 offen offset:2048 sc1
    v_mul_f32 v6, v6, v194
    v_mul_f32 v7, v7, v194
    v_and_b32 v9, 0xffff0000, v188
    v_lshlrev_b32 v8, 16, v188
    v_mfma_f32_32x32x16_bf16 v[112:127], a[72:75], v[64:67], v[112:127]
    v_and_b32 v11, 0xffff0000, v189
    v_lshlrev_b32 v10, 16, v189
    v_mul_f32 v8, v8, v104
    v_mfma_f32_32x32x16_bf16 v[144:159], a[76:79], v[64:67], v[144:159]
    v_mul_f32 v9, v9, v105
    v_mul_f32 v10, v10, v106
    v_mul_f32 v11, v11, v107
    v_mfma_f32_32x32x16_bf16 v[112:127], a[80:83], v[72:75], v[112:127]
    v_mul_f32 v8, v8, v195
    v_mul_f32 v9, v9, v195
    v_mul_f32 v10, v10, v195
    v_mul_f32 v11, v11, v195
    v_mfma_f32_32x32x16_bf16 v[144:159], a[84:87], v[72:75], v[144:159]
    v_and_b32 v13, 0xffff0000, v190
    v_lshlrev_b32 v12, 16, v190
    v_and_b32 v15, 0xffff0000, v191
    v_mfma_f32_32x32x16_bf16 v[112:127], a[0:3], v[80:83], v[112:127]
    v_lshlrev_b32 v14, 16, v191
    v_mul_f32 v12, v12, v104
    v_mul_f32 v13, v13, v105
    v_mul_f32 v14, v14, v106
    v_mfma_f32_32x32x16_bf16 v[144:159], a[4:7], v[80:83], v[144:159]
    v_mul_f32 v15, v15, v107
    v_mul_f32 v12, v12, v196
    v_mul_f32 v13, v13, v196
    v_mfma_f32_32x32x16_bf16 v[112:127], a[8:11], v[88:91], v[112:127]
    v_mul_f32 v14, v14, v196
    v_mul_f32 v15, v15, v196
    v_and_b32 v109, 0xffff0000, v192
    v_mfma_f32_32x32x16_bf16 v[144:159], a[12:15], v[88:91], v[144:159]
    v_lshlrev_b32 v108, 16, v192
    v_and_b32 v111, 0xffff0000, v193
    v_lshlrev_b32 v110, 16, v193
    v_mul_f32 v108, v108, v104
    v_mfma_f32_32x32x16_bf16 v[112:127], a[16:19], v[96:99], v[112:127]
    v_mul_f32 v109, v109, v105
    v_mul_f32 v110, v110, v106
    v_mul_f32 v111, v111, v107
    v_mfma_f32_32x32x16_bf16 v[144:159], a[20:23], v[96:99], v[144:159]
    v_mul_f32 v108, v108, v197
    v_mul_f32 v109, v109, v197
    v_mul_f32 v110, v110, v197
    v_mul_f32 v111, v111, v197
    s_waitcnt vmcnt(0)
    s_mov_b32 s99, 0
.Lsp_27:
    v_max3_u32 v178, v20, v28, v36
    v_max3_u32 v178, v178, v44, v52
    v_max3_u32 v178, v178, v60, v68
    v_max3_u32 v178, v178, v76, v84
    v_max3_u32 v178, v178, v92, v100
    v_cmp_eq_u32 vcc, -1, v178
    s_nop 0
    s_cmp_eq_u64 vcc, 0
    s_cbranch_scc1 .Lsd_28
    s_add_u32 s98, s74, 45056
    buffer_load_dwordx4 v[20:23], v2, s[16:19], s98 offen offset:0 sc1
    buffer_load_dwordx4 v[28:31], v2, s[16:19], s98 offen offset:1024 sc1
    buffer_load_dwordx4 v[36:39], v2, s[16:19], s98 offen offset:2048 sc1
    buffer_load_dwordx4 v[44:47], v2, s[16:19], s98 offen offset:3072 sc1
    s_add_u32 s98, s74, 49152
    buffer_load_dwordx4 v[52:55], v2, s[16:19], s98 offen offset:0 sc1
    buffer_load_dwordx4 v[60:63], v2, s[16:19], s98 offen offset:1024 sc1
    buffer_load_dwordx4 v[68:71], v2, s[16:19], s98 offen offset:2048 sc1
    buffer_load_dwordx4 v[76:79], v2, s[16:19], s98 offen offset:3072 sc1
    s_add_u32 s98, s74, 53248
    buffer_load_dwordx4 v[84:87], v2, s[16:19], s98 offen offset:0 sc1
    buffer_load_dwordx4 v[92:95], v2, s[16:19], s98 offen offset:1024 sc1
    buffer_load_dwordx4 v[100:103], v185, s[16:19], s98 offen offset:2048 sc1
    s_waitcnt vmcnt(0)
    s_add_u32 s99, s99, 1
    s_cmp_lt_u32 s99, 200000
    s_cbranch_scc1 .Lsp_27
.Lsd_28:
    v_mfma_f32_32x32x16_bf16 v[128:143], a[24:27], v[20:23], v[128:143]
    v_mfma_f32_32x32x16_bf16 v[128:143], a[32:35], v[28:31], v[128:143]
    v_mfma_f32_32x32x16_bf16 v[128:143], a[40:43], v[36:39], v[128:143]
    v_mfma_f32_32x32x16_bf16 v[128:143], a[48:51], v[44:47], v[128:143]
    ds_write_b128 v180, v[112:115] offset:0
    v_mfma_f32_32x32x16_bf16 v[128:143], a[56:59], v[52:55], v[128:143]
    ds_write_b128 v181, v[116:119] offset:0
    v_mfma_f32_32x32x16_bf16 v[128:143], a[64:67], v[60:63], v[128:143]
    ds_write_b128 v182, v[120:123] offset:0
    v_mfma_f32_32x32x16_bf16 v[128:143], a[72:75], v[68:71], v[128:143]
    ds_write_b128 v183, v[124:127] offset:0
    v_mfma_f32_32x32x16_bf16 v[128:143], a[80:83], v[76:79], v[128:143]
    ds_write_b128 v180, v[144:147] offset:128
    v_mfma_f32_32x32x16_bf16 v[128:143], a[0:3], v[84:87], v[128:143]
    ds_write_b128 v181, v[148:151] offset:128
    v_mfma_f32_32x32x16_bf16 v[128:143], a[8:11], v[92:95], v[128:143]
    ds_write_b128 v182, v[152:155] offset:128
    v_mfma_f32_32x32x16_bf16 v[128:143], a[16:19], v[100:103], v[128:143]
    ds_write_b128 v183, v[156:159] offset:128
    v_mfma_f32_32x32x16_bf16 v[160:175], a[28:31], v[20:23], v[160:175]
    v_mfma_f32_32x32x16_bf16 v[160:175], a[36:39], v[28:31], v[160:175]
    v_mfma_f32_32x32x16_bf16 v[160:175], a[44:47], v[36:39], v[160:175]
    v_mfma_f32_32x32x16_bf16 v[160:175], a[52:55], v[44:47], v[160:175]
    v_mfma_f32_32x32x16_bf16 v[160:175], a[60:63], v[52:55], v[160:175]
    v_mfma_f32_32x32x16_bf16 v[160:175], a[68:71], v[60:63], v[160:175]
    s_nop 4
    ds_write_b128 v180, v[128:131] offset:8192
    v_mfma_f32_32x32x16_bf16 v[160:175], a[76:79], v[68:71], v[160:175]
    v_mfma_f32_32x32x16_bf16 v[160:175], a[84:87], v[76:79], v[160:175]
    ds_write_b128 v181, v[132:135] offset:8192
    v_mfma_f32_32x32x16_bf16 v[160:175], a[4:7], v[84:87], v[160:175]
    v_mfma_f32_32x32x16_bf16 v[160:175], a[12:15], v[92:95], v[160:175]
    ds_write_b128 v182, v[136:139] offset:8192
    v_mfma_f32_32x32x16_bf16 v[160:175], a[20:23], v[100:103], v[160:175]
    ds_write_b128 v183, v[140:143] offset:8192
    s_nop 10
    ds_write_b128 v180, v[160:163] offset:8320
    ds_write_b128 v181, v[164:167] offset:8320
    ds_write_b128 v182, v[168:171] offset:8320
    ds_write_b128 v183, v[172:175] offset:8320
    s_waitcnt lgkmcnt(0)
    s_barrier
    ds_read_b128 v[16:19], v230 offset:0
    ds_read_b128 v[20:23], v230 offset:40960
    ds_read_b128 v[24:27], v232 offset:0
    ds_read_b128 v[28:31], v232 offset:40960
    ds_read_b128 v[32:35], v231 offset:1024
    ds_read_b128 v[36:39], v231 offset:41984
    ds_read_b128 v[40:43], v233 offset:1024
    ds_read_b128 v[44:47], v233 offset:41984
    ds_read_b128 v[48:51], v230 offset:2048
    ds_read_b128 v[52:55], v230 offset:43008
    ds_read_b128 v[56:59], v232 offset:2048
    ds_read_b128 v[60:63], v232 offset:43008
    s_waitcnt lgkmcnt(11)
    ds_read_b128 v[64:67], v231 offset:3072
    ds_read_b128 v[68:71], v231 offset:44032
    ds_read_b128 v[72:75], v233 offset:3072
    ds_read_b128 v[76:79], v233 offset:44032
    s_lshl_b32 s76, s76, 1
    s_waitcnt lgkmcnt(12)
    v_pk_add_f32 v[16:17], v[16:17], v[20:21]
    v_pk_add_f32 v[24:25], v[24:25], v[28:29]
    v_pk_add_f32 v[18:19], v[18:19], v[22:23]
    v_pk_add_f32 v[26:27], v[26:27], v[30:31]
    v_pk_add_f32 v[16:17], v[16:17], v[4:5]
    v_pk_add_f32 v[18:19], v[18:19], v[6:7]
    v_pk_add_f32 v[16:17], v[16:17], v[24:25]
    v_pk_add_f32 v[18:19], v[18:19], v[26:27]
    s_add_u32 s60, s76, 0
    buffer_store_dwordx4 v[16:19], v184, s[32:35], s60 offen sc1
    s_waitcnt lgkmcnt(8)
    v_pk_add_f32 v[32:33], v[32:33], v[36:37]
    v_pk_add_f32 v[40:41], v[40:41], v[44:45]
    v_pk_add_f32 v[34:35], v[34:35], v[38:39]
    v_pk_add_f32 v[42:43], v[42:43], v[46:47]
    v_pk_add_f32 v[32:33], v[32:33], v[8:9]
    v_pk_add_f32 v[34:35], v[34:35], v[10:11]
    v_pk_add_f32 v[32:33], v[32:33], v[40:41]
    v_pk_add_f32 v[34:35], v[34:35], v[42:43]
    s_add_u32 s60, s76, 8192
    buffer_store_dwordx4 v[32:35], v184, s[32:35], s60 offen sc1
    s_waitcnt lgkmcnt(4)
    v_pk_add_f32 v[48:49], v[48:49], v[52:53]
    v_pk_add_f32 v[56:57], v[56:57], v[60:61]
    v_pk_add_f32 v[50:51], v[50:51], v[54:55]
    v_pk_add_f32 v[58:59], v[58:59], v[62:63]
    v_pk_add_f32 v[48:49], v[48:49], v[12:13]
    v_pk_add_f32 v[50:51], v[50:51], v[14:15]
    v_pk_add_f32 v[48:49], v[48:49], v[56:57]
    v_pk_add_f32 v[50:51], v[50:51], v[58:59]
    s_add_u32 s60, s76, 16384
    buffer_store_dwordx4 v[48:51], v184, s[32:35], s60 offen sc1
    s_waitcnt lgkmcnt(0)
    v_pk_add_f32 v[64:65], v[64:65], v[68:69]
    v_pk_add_f32 v[72:73], v[72:73], v[76:77]
    v_pk_add_f32 v[66:67], v[66:67], v[70:71]
    v_pk_add_f32 v[74:75], v[74:75], v[78:79]
    v_pk_add_f32 v[64:65], v[64:65], v[108:109]
    v_pk_add_f32 v[66:67], v[66:67], v[110:111]
    v_pk_add_f32 v[64:65], v[64:65], v[72:73]
    v_pk_add_f32 v[66:67], v[66:67], v[74:75]
    s_add_u32 s60, s76, 24576
    buffer_store_dwordx4 v[64:67], v184, s[32:35], s60 offen sc1
    s_lshl_b32 s60, s59, 3
    s_add_u32 s60, s60, s58
    s_lshl_b32 s60, s60, 2
    s_add_u32 s60, s60, s56
    s_cmp_eq_u32 s60, 1020
    s_cbranch_scc0 .Lne_29
    s_mov_b32 s60, 0
    buffer_store_dword v220, v221, s[16:19], s60 offen sc1
.Lne_29:
.Lend_1:
    s_endpgm
.section .rodata,"a"
.p2align 6
.amdhsa_kernel gated_mix__ssm_conv_s5__mixer_gmlp__prompt_kernel
  .amdhsa_next_free_vgpr 512
  .amdhsa_next_free_sgpr 102
  .amdhsa_accum_offset 256
  .amdhsa_group_segment_fixed_size 0
  .amdhsa_kernarg_size 144
  .amdhsa_user_sgpr_count 2
  .amdhsa_user_sgpr_kernarg_segment_ptr 1
  .amdhsa_system_sgpr_workgroup_id_x 1
  .amdhsa_float_denorm_mode_32 3
.end_amdhsa_kernel
```
